```python
import torch

def _softmax(x, axis=-1):
    return torch.softmax(x, dim=axis)

def _gelu(x):
    return torch.nn.functional.gelu(x, approximate='tanh')

def _silu(x):
    return torch.nn.functional.silu(x)

def _sigmoid(x):
    return torch.sigmoid(x)

def _layernorm(x, axis=-1, eps=1e-05):
    m = x.mean(dim=axis, keepdim=True)
    v = x.var(dim=axis, keepdim=True, unbiased=False)
    return (x - m) / torch.sqrt(v + eps)

def _scatter_add(tgt, idx, src, axis=0):
    return tgt.clone().index_add_(axis, idx, src)

def _segment_sum(src, seg, n):
    out = torch.zeros((n,) + src.shape[1:], dtype=src.dtype)
    return out.index_add_(0, seg, src)

def _pad(x, pw):
    flat = tuple((v for pair in reversed(pw) for v in pair))
    return torch.nn.functional.pad(x, flat)
kernel_name = 'adaLN_cond__spectral_gfnet__moe_arch_mod__prompt'

def setup_inputs():

    _w = lambda a: (lambda t: t.to(torch.bfloat16) if t.is_floating_point() else t)(torch.as_tensor(a))

    def _A_setup():
        B, S, D = (1, 2048, 640)
        Df = D // 2 + 1
        return {'x': _w((lambda *s: torch.randn(*s, dtype=torch.bfloat16) * 0.05)(B, S, D)), 'w_r': _w((lambda *s: torch.randn(*s, dtype=torch.bfloat16) * 3.2)(S, Df) * 0.02), 'w_i': _w((lambda *s: torch.randn(*s, dtype=torch.bfloat16) * 3.2)(S, Df) * 0.02)}
    _A_in = _A_setup()

    def _B_setup():
        B, S, D, F, C = (1, 2048, 640, 1728, 8)
        return {'x': _w((lambda *s: torch.randn(*s, dtype=torch.bfloat16) * 0.05)(B, S, D)), 'w_r': _w((lambda *s: torch.randn(*s, dtype=torch.bfloat16) * 0.2)(D)), 'w_gate': _w((lambda *s: torch.randn(*s, dtype=torch.bfloat16) * 0.2)(D, F)), 'w_up': _w((lambda *s: torch.randn(*s, dtype=torch.bfloat16) * 0.2)(D, F)), 'w_down': _w((lambda *s: torch.randn(*s, dtype=torch.bfloat16) * 0.2)(F, D))}
    _B_in = _B_setup()
    return {'A_x': _A_in['x'], 'A_w_r': _A_in['w_r'], 'A_w_i': _A_in['w_i'], 'B_x': _B_in['x'], 'B_w_r': _B_in['w_r'], 'B_w_gate': _B_in['w_gate'], 'B_w_up': _B_in['w_up'], 'B_w_down': _B_in['w_down'], 'c': _w((lambda *s: torch.randn(*s, dtype=torch.bfloat16) * 0.1)(1, 640) * 8.0), 'w_mod': _w((lambda *s: torch.randn(*s, dtype=torch.bfloat16) * 0.1)(640, 6 * 640) * 640 ** (-0.5) * 8.0)}

def reference(A_x, A_w_r, A_w_i, B_x, B_w_r, B_w_gate, B_w_up, B_w_down, c, w_mod):

    def _A_ref(x, w_r, w_i):
        B, S, D = x.shape
        X = (lambda x, axes=(-2, -1): torch.fft.rfft2(x.float(), dim=axes))(x, axes=(-2, -1))
        W = w_r + 1j * w_i
        X = X * W
        y = (lambda x, s, axes=(-2, -1): torch.fft.irfft2(x, s=s, dim=axes).to(torch.bfloat16))(X, (S, D), axes=(-2, -1))
        return y

    def _B_ref(x, w_r, w_gate, w_up, w_down):
        B, S, D = x.shape
        C = 8
        r = x @ w_r
        idx = torch.argsort(-r, axis=-1)[:, :C]
        idx_e = (lambda x, n, axis: torch.repeat_interleave(x, n, dim=axis))(idx.reshape(B, C, 1), D, axis=2)
        x_sel = (lambda x, i, axis: torch.take_along_dim(x, i, dim=axis))(x, idx_e, axis=1)
        g = _silu(x_sel @ w_gate)
        u = x_sel @ w_up
        y = g * u @ w_down
        r_sel = _sigmoid((lambda x, i, axis: torch.take_along_dim(x, i, dim=axis))(r, idx, axis=1))
        y = y * r_sel.reshape(B, C, 1)
        b_off = (torch.arange(B) * S).reshape(B, 1)
        flat_idx = (idx + b_off).reshape(B * C)
        zero = (x * 0.0).reshape(B * S, D)
        upd = _scatter_add(zero, flat_idx, y.reshape(B * C, D), axis=0)
        return x + upd.reshape(B, S, D)
    x = A_x
    mod = (_silu(c) @ w_mod).reshape(c.shape[0], 6, 1, -1)
    sa, ca, ga, sb, cb, gb = (mod[:, 0].clone(), mod[:, 1].clone(), mod[:, 2].clone(), mod[:, 3].clone(), mod[:, 4].clone(), mod[:, 5].clone())
    h = _layernorm(x, axis=-1) * (1 + ca) + sa
    x = x + ga * _A_ref(h, A_w_r, A_w_i)
    h = _layernorm(x, axis=-1) * (1 + cb) + sb
    x = x + gb * _B_ref(h, B_w_r, B_w_gate, B_w_up, B_w_down)
    return x
```

```asm
; @launch kernel=fused_kernel grid=(256,1,1) block=(384,1,1) lds=147120
.amdgcn_target "amdgcn-amd-amdhsa--gfx950"
.text
.globl fused_kernel
.p2align 8
.type fused_kernel,@function
fused_kernel:
    s_cmp_ge_u32 s2, 256
    s_cbranch_scc1 L_exit
    s_load_dwordx16 s[60:75], s[0:1], 0
    s_load_dwordx8 s[76:83], s[0:1], 64
    s_load_dwordx2 s[84:85], s[0:1], 96
    v_lshrrev_b32 v1, 6, v0
    s_nop 0
    v_readfirstlane_b32 s3, v1
    v_and_b32 v1, 63, v0
    s_and_b32 s6, s2, 7
    s_lshr_b32 s5, s2, 3
    s_lshl_b32 s4, s6, 5
    s_add_u32 s4, s4, s5
    s_mov_b32 s15, 0xffff0000
    v_lshlrev_b32 v7, 4, v0
    v_mov_b32 v31, 0x3ff
    s_getpc_b64 s[16:17]
Lpc:
    s_add_u32 s16, s16, fused_kernel-Lpc
    s_addc_u32 s17, s17, -1
    s_mov_b32 s18, code_end-fused_kernel
    s_mov_b32 s19, 0x00020000
    s_mul_i32 s8, s3, 43
    s_add_u32 s8, s8, s5
    s_and_b32 s8, s8, 63
    s_lshl_b32 s8, s8, 10
    v_lshlrev_b32 v2, 4, v1
    buffer_load_dwordx4 v[248:251], v2, s[16:19], s8 offen
    s_cmp_eq_u32 s3, 5
    s_cbranch_scc1 L_svc
    s_cmp_eq_u32 s3, 4
    s_cbranch_scc1 L_w4
    v_mov_b32 v46, 0
    v_mov_b32 v47, 0
    v_mov_b32 v48, 0
    v_mov_b32 v49, 0
    v_mov_b32 v50, 0
    v_mov_b32 v51, 0
    v_mov_b32 v52, 0
    v_mov_b32 v53, 0
    v_mov_b32 v54, 0
    v_mov_b32 v55, 0
    v_mov_b32 v56, 0
    v_mov_b32 v57, 0
    v_mov_b32 v58, 0
    v_mov_b32 v59, 0
    v_mov_b32 v60, 0
    v_mov_b32 v61, 0
    v_mov_b32 v62, 0
    v_mov_b32 v63, 0
    v_mov_b32 v64, 0
    v_mov_b32 v65, 0
    v_lshlrev_b32 v66, 1, v1
    s_lshl_b32 s8, s3, 9
    s_add_u32 s8, s8, s4
    s_mul_i32 s8, s8, 1280
    s_add_u32 s9, s8, 327680
    s_waitcnt lgkmcnt(0)
    s_load_dwordx2 s[58:59], s[84:85], 61440
    s_mov_b32 s16, s60
    s_mov_b32 s17, s61
    s_mov_b32 s18, 0x280000
    s_mov_b32 s19, 0x00020000
    buffer_load_short_d16_hi v46, v66, s[16:19], s8 offen offset:0
    buffer_load_short_d16_hi v47, v66, s[16:19], s9 offen offset:0
    buffer_load_short_d16_hi v48, v66, s[16:19], s8 offen offset:128
    buffer_load_short_d16_hi v49, v66, s[16:19], s9 offen offset:128
    buffer_load_short_d16_hi v50, v66, s[16:19], s8 offen offset:256
    buffer_load_short_d16_hi v51, v66, s[16:19], s9 offen offset:256
    buffer_load_short_d16_hi v52, v66, s[16:19], s8 offen offset:384
    buffer_load_short_d16_hi v53, v66, s[16:19], s9 offen offset:384
    buffer_load_short_d16_hi v54, v66, s[16:19], s8 offen offset:512
    buffer_load_short_d16_hi v55, v66, s[16:19], s9 offen offset:512
    buffer_load_short_d16_hi v56, v66, s[16:19], s8 offen offset:640
    buffer_load_short_d16_hi v57, v66, s[16:19], s9 offen offset:640
    buffer_load_short_d16_hi v58, v66, s[16:19], s8 offen offset:768
    buffer_load_short_d16_hi v59, v66, s[16:19], s9 offen offset:768
    buffer_load_short_d16_hi v60, v66, s[16:19], s8 offen offset:896
    buffer_load_short_d16_hi v61, v66, s[16:19], s9 offen offset:896
    buffer_load_short_d16_hi v62, v66, s[16:19], s8 offen offset:1024
    buffer_load_short_d16_hi v63, v66, s[16:19], s9 offen offset:1024
    buffer_load_short_d16_hi v64, v66, s[16:19], s8 offen offset:1152
    buffer_load_short_d16_hi v65, v66, s[16:19], s9 offen offset:1152
    s_mov_b32 s32, 0x3f3504f3
    s_mov_b32 s33, 0x3f3504f3
    s_mov_b32 s34, 0x3e9e377a
    s_mov_b32 s35, 0x3e9e377a
    s_mov_b32 s36, 0xbf4f1bbd
    s_mov_b32 s37, 0xbf4f1bbd
    s_mov_b32 s38, 0x3f737871
    s_mov_b32 s39, 0x3f737871
    s_mov_b32 s40, 0x3f167918
    s_mov_b32 s41, 0x3f167918
    s_mov_b32 s42, 0x34cccccd
    s_mov_b32 s43, 0x34cccccd
    s_movk_i32 s44, 0x3f80
    s_mov_b32 s45, 1.0
    v_and_b32 v2, 7, v0
    s_lshl_b32 s14, s3, 3
    v_add_u32 v15, s14, v2
    v_lshrrev_b32 v14, 3, v1
    v_mul_u32_u24 v3, 608, v15
    v_mul_u32_u24 v4, 72, v14
    v_add_u32 v4, v4, v3
    v_lshl_add_u32 v3, v14, 3, v3
    v_lshrrev_b32 v5, 3, v15
    v_mul_u32_u24 v6, 5, v14
    v_add_u32 v5, v5, v6
    v_bfe_u32 v68, v15, 2, 1
    v_sub_u32 v6, 40, v5
    v_sub_u32 v6, v6, v68
    v_mul_u32_u24 v68, 2576, v68
    v_and_b32 v15, 3, v15
    v_mul_u32_u24 v9, 5152, v15
    v_add3_u32 v9, v9, v68, 0
    v_add_u32 v9, 24320, v9
    v_and_b32 v15, 1, v15
    v_lshlrev_b32 v15, 3, v15
    v_lshl_add_u32 v5, v5, 4, v9
    v_add_u32 v5, v5, v15
    v_lshl_add_u32 v6, v6, 4, v9
    v_xor_b32 v15, 8, v15
    v_add_u32 v6, v6, v15
    s_mul_i32 s14, s3, 4608
    s_add_u32 s14, s14, 24320
    v_lshlrev_b32 v11, 3, v1
    v_add_u32 v11, s14, v11
    v_mul_u32_u24 v12, 576, v14
    v_add_u32 v12, s14, v12
    v_mul_u32_u24 v13, 72, v2
    v_add_u32 v13, v13, v12
    v_lshl_add_u32 v12, v2, 3, v12
    v_mul_u32_u24 v15, 0x3334, v0
    v_lshrrev_b32 v15, 16, v15
    v_mul_u32_u24 v10, 5, v15
    v_sub_u32 v10, v0, v10
    v_mul_u32_u24 v8, 20608, v15
    v_lshl_add_u32 v8, v10, 4, v8
    v_mul_u32_u24 v29, 80, v15
    v_lshl_add_u32 v29, v10, 4, v29
    v_mul_u32_u24 v9, 4112, v10
    v_lshl_add_u32 v9, v15, 4, v9
    s_mul_i32 s14, s3, 4112
    v_lshlrev_b32 v10, 4, v1
    v_add_u32 v10, s14, v10
    s_mul_i32 s14, s3, 608
    v_lshlrev_b32 v2, 3, v1
    v_add_u32 v2, s14, v2
    s_lshl_b32 s14, s3, 5
    v_and_b32 v68, 31, v1
    v_add_u32 v68, s14, v68
    v_lshrrev_b32 v69, 5, v1
    v_mul_u32_u24 v26, 2576, v69
    v_lshl_add_u32 v26, v68, 4, v26
    v_mul_u32_u24 v27, 2560, v69
    v_lshl_add_u32 v27, v68, 4, v27
    v_mul_u32_u24 v15, 0x3334, v68
    v_lshrrev_b32 v15, 16, v15
    v_mul_u32_u24 v28, 20528, v15
    v_lshl_add_u32 v28, v68, 4, v28
    v_mul_u32_u24 v15, 659456, v69
    v_add_u32 v28, v28, v15
    s_cmp_eq_u32 s3, 0
    s_cselect_b32 s86, 1, 0
    s_cselect_b32 s12, 15, 0
    s_mov_b32 s87, 0
    s_mov_b32 s13, 0
    v_mul_u32_u24 v15, s4, v1
    v_cvt_f32_u32 v15, v15
    v_mul_f32 v15, 0x3a000000, v15
    v_fract_f32 v15, v15
    v_cos_f32 v68, v15
    v_sin_f32 v69, v15
    v_readlane_b32 s46, v68, 1
    v_readlane_b32 s47, v69, 1
    v_readlane_b32 s48, v68, 2
    v_readlane_b32 s49, v69, 2
    v_readlane_b32 s50, v68, 3
    v_readlane_b32 s51, v69, 3
    v_readlane_b32 s52, v68, 4
    v_readlane_b32 s53, v69, 4
    v_readlane_b32 s54, v68, 5
    v_readlane_b32 s55, v69, 5
    v_readlane_b32 s56, v68, 6
    v_readlane_b32 s57, v69, 6
    v_readlane_b32 s70, v68, 7
    v_readlane_b32 s71, v69, 7
    v_mul_u32_u24 v15, 1, v14
    v_cvt_f32_u32 v15, v15
    v_mul_f32 v15, 0x3c800000, v15
    v_fract_f32 v15, v15
    v_cos_f32 v32, v15
    v_sin_f32 v33, v15
    v_mul_u32_u24 v15, 2, v14
    v_cvt_f32_u32 v15, v15
    v_mul_f32 v15, 0x3c800000, v15
    v_fract_f32 v15, v15
    v_cos_f32 v34, v15
    v_sin_f32 v35, v15
    v_mul_u32_u24 v15, 3, v14
    v_cvt_f32_u32 v15, v15
    v_mul_f32 v15, 0x3c800000, v15
    v_fract_f32 v15, v15
    v_cos_f32 v36, v15
    v_sin_f32 v37, v15
    v_mul_u32_u24 v15, 4, v14
    v_cvt_f32_u32 v15, v15
    v_mul_f32 v15, 0x3c800000, v15
    v_fract_f32 v15, v15
    v_cos_f32 v38, v15
    v_sin_f32 v39, v15
    v_mul_u32_u24 v15, 5, v14
    v_cvt_f32_u32 v15, v15
    v_mul_f32 v15, 0x3c800000, v15
    v_fract_f32 v15, v15
    v_cos_f32 v40, v15
    v_sin_f32 v41, v15
    v_mul_u32_u24 v15, 6, v14
    v_cvt_f32_u32 v15, v15
    v_mul_f32 v15, 0x3c800000, v15
    v_fract_f32 v15, v15
    v_cos_f32 v42, v15
    v_sin_f32 v43, v15
    v_mul_u32_u24 v15, 7, v14
    v_cvt_f32_u32 v15, v15
    v_mul_f32 v15, 0x3c800000, v15
    v_fract_f32 v15, v15
    v_cos_f32 v44, v15
    v_sin_f32 v45, v15
    s_mov_b32 s24, s84
    s_mov_b32 s25, s85
    s_mov_b32 s26, 0x50000
    s_mov_b32 s27, 0x00020000
    v_mul_u32_u24 v70, 1, v1
    v_cvt_f32_u32 v70, v70
    v_mul_f32 v70, 0x3acccccd, v70
    v_fract_f32 v70, v70
    v_cos_f32 v68, v70
    v_sin_f32 v69, v70
    v_mul_u32_u24 v70, 2, v1
    v_cvt_f32_u32 v70, v70
    v_mul_f32 v70, 0x3acccccd, v70
    v_fract_f32 v70, v70
    v_cos_f32 v72, v70
    v_sin_f32 v73, v70
    v_mul_u32_u24 v70, 3, v1
    v_cvt_f32_u32 v70, v70
    v_mul_f32 v70, 0x3acccccd, v70
    v_fract_f32 v70, v70
    v_cos_f32 v74, v70
    v_sin_f32 v75, v70
    v_mul_u32_u24 v70, 4, v1
    v_cvt_f32_u32 v70, v70
    v_mul_f32 v70, 0x3acccccd, v70
    v_fract_f32 v70, v70
    v_cos_f32 v76, v70
    v_sin_f32 v77, v70
    v_mul_u32_u24 v70, 5, v1
    v_cvt_f32_u32 v70, v70
    v_mul_f32 v70, 0x3acccccd, v70
    v_fract_f32 v70, v70
    v_cos_f32 v78, v70
    v_sin_f32 v79, v70
    v_mul_u32_u24 v70, 6, v1
    v_cvt_f32_u32 v70, v70
    v_mul_f32 v70, 0x3acccccd, v70
    v_fract_f32 v70, v70
    v_cos_f32 v80, v70
    v_sin_f32 v81, v70
    v_mul_u32_u24 v70, 7, v1
    v_cvt_f32_u32 v70, v70
    v_mul_f32 v70, 0x3acccccd, v70
    v_fract_f32 v70, v70
    v_cos_f32 v82, v70
    v_sin_f32 v83, v70
    v_mul_u32_u24 v70, 8, v1
    v_cvt_f32_u32 v70, v70
    v_mul_f32 v70, 0x3acccccd, v70
    v_fract_f32 v70, v70
    v_cos_f32 v84, v70
    v_sin_f32 v85, v70
    v_mul_u32_u24 v70, 9, v1
    v_cvt_f32_u32 v70, v70
    v_mul_f32 v70, 0x3acccccd, v70
    v_fract_f32 v70, v70
    v_cos_f32 v86, v70
    v_sin_f32 v87, v70
    v_mov_b32 v88, 0x3acccccd
    v_mov_b32 v89, 0x3acccccd
    s_mov_b32 s14, 0x07060302
    s_waitcnt vmcnt(0)
    s_barrier
    v_perm_b32 v16, v47, v46, s14
    v_perm_b32 v17, v49, v48, s14
    v_perm_b32 v18, v51, v50, s14
    v_perm_b32 v19, v53, v52, s14
    v_perm_b32 v20, v55, v54, s14
    v_perm_b32 v21, v57, v56, s14
    v_perm_b32 v22, v59, v58, s14
    v_perm_b32 v23, v61, v60, s14
    v_perm_b32 v24, v63, v62, s14
    v_perm_b32 v25, v65, v64, s14
    v_pk_add_f32 v[90:91], v[46:47], v[48:49]
    v_pk_add_f32 v[90:91], v[90:91], v[50:51]
    v_pk_add_f32 v[90:91], v[90:91], v[52:53]
    v_pk_add_f32 v[90:91], v[90:91], v[54:55]
    v_pk_add_f32 v[90:91], v[90:91], v[56:57]
    v_pk_add_f32 v[90:91], v[90:91], v[58:59]
    v_pk_add_f32 v[90:91], v[90:91], v[60:61]
    v_pk_add_f32 v[90:91], v[90:91], v[62:63]
    v_pk_add_f32 v[90:91], v[90:91], v[64:65]
    s_nop 1
    v_permlane32_swap_b32 v90, v91
    v_add_f32 v90, v90, v91
    v_mov_b32 v92, v90
    s_nop 1
    v_permlane16_swap_b32 v90, v92
    v_add_f32 v90, v90, v92
    s_nop 1
    v_add_f32_dpp v90, v90, v90 row_ror:8 row_mask:0xf bank_mask:0xf
    s_nop 1
    v_add_f32_dpp v90, v90, v90 row_ror:4 row_mask:0xf bank_mask:0xf
    s_nop 1
    v_add_f32_dpp v90, v90, v90 row_ror:2 row_mask:0xf bank_mask:0xf
    s_nop 1
    v_add_f32_dpp v90, v90, v90 row_ror:1 row_mask:0xf bank_mask:0xf
    s_nop 0
    v_readlane_b32 s28, v90, 0
    v_readlane_b32 s29, v90, 32
    s_nop 1
    v_pk_mul_f32 v[94:95], s[28:29], v[88:89]
    v_pk_add_f32 v[96:97], v[46:47], v[94:95] neg_lo:[0,1] neg_hi:[0,1]
    v_pk_mul_f32 v[90:91], v[96:97], v[96:97]
    v_pk_add_f32 v[96:97], v[48:49], v[94:95] neg_lo:[0,1] neg_hi:[0,1]
    v_pk_fma_f32 v[90:91], v[96:97], v[96:97], v[90:91]
    v_pk_add_f32 v[96:97], v[50:51], v[94:95] neg_lo:[0,1] neg_hi:[0,1]
    v_pk_fma_f32 v[90:91], v[96:97], v[96:97], v[90:91]
    v_pk_add_f32 v[96:97], v[52:53], v[94:95] neg_lo:[0,1] neg_hi:[0,1]
    v_pk_fma_f32 v[90:91], v[96:97], v[96:97], v[90:91]
    v_pk_add_f32 v[96:97], v[54:55], v[94:95] neg_lo:[0,1] neg_hi:[0,1]
    v_pk_fma_f32 v[90:91], v[96:97], v[96:97], v[90:91]
    v_pk_add_f32 v[96:97], v[56:57], v[94:95] neg_lo:[0,1] neg_hi:[0,1]
    v_pk_fma_f32 v[90:91], v[96:97], v[96:97], v[90:91]
    v_pk_add_f32 v[96:97], v[58:59], v[94:95] neg_lo:[0,1] neg_hi:[0,1]
    v_pk_fma_f32 v[90:91], v[96:97], v[96:97], v[90:91]
    v_pk_add_f32 v[96:97], v[60:61], v[94:95] neg_lo:[0,1] neg_hi:[0,1]
    v_pk_fma_f32 v[90:91], v[96:97], v[96:97], v[90:91]
    v_pk_add_f32 v[96:97], v[62:63], v[94:95] neg_lo:[0,1] neg_hi:[0,1]
    v_pk_fma_f32 v[90:91], v[96:97], v[96:97], v[90:91]
    v_pk_add_f32 v[96:97], v[64:65], v[94:95] neg_lo:[0,1] neg_hi:[0,1]
    v_pk_fma_f32 v[90:91], v[96:97], v[96:97], v[90:91]
    s_nop 1
    v_permlane32_swap_b32 v90, v91
    v_add_f32 v90, v90, v91
    v_mov_b32 v92, v90
    s_nop 1
    v_permlane16_swap_b32 v90, v92
    v_add_f32 v90, v90, v92
    s_nop 1
    v_add_f32_dpp v90, v90, v90 row_ror:8 row_mask:0xf bank_mask:0xf
    s_nop 1
    v_add_f32_dpp v90, v90, v90 row_ror:4 row_mask:0xf bank_mask:0xf
    s_nop 1
    v_add_f32_dpp v90, v90, v90 row_ror:2 row_mask:0xf bank_mask:0xf
    s_nop 1
    v_add_f32_dpp v90, v90, v90 row_ror:1 row_mask:0xf bank_mask:0xf
    s_nop 0
    v_readlane_b32 s30, v90, 0
    v_readlane_b32 s31, v90, 32
    s_nop 1
    v_pk_mul_f32 v[96:97], s[30:31], v[88:89]
    v_cvt_pk_bf16_f32 v92, v94, v95
    v_lshlrev_b32 v94, 16, v92
    v_and_b32 v95, s15, v92
    v_cvt_pk_bf16_f32 v92, v96, v97
    v_lshlrev_b32 v96, 16, v92
    v_and_b32 v97, s15, v92
    v_add_f32 v96, 0x3727c5ac, v96
    v_add_f32 v97, 0x3727c5ac, v97
    v_cvt_pk_bf16_f32 v92, v96, v97
    v_lshlrev_b32 v96, 16, v92
    v_and_b32 v97, s15, v92
    v_sqrt_f32 v96, v96
    v_sqrt_f32 v97, v97
    s_nop 0
    v_cvt_pk_bf16_f32 v92, v96, v97
    v_lshlrev_b32 v96, 16, v92
    v_and_b32 v97, s15, v92
    v_rcp_f32 v90, v96
    v_rcp_f32 v91, v97
    v_pk_add_f32 v[46:47], v[46:47], v[94:95] neg_lo:[0,1] neg_hi:[0,1]
    v_cvt_pk_bf16_f32 v98, v46, v47
    v_pk_add_f32 v[48:49], v[48:49], v[94:95] neg_lo:[0,1] neg_hi:[0,1]
    v_cvt_pk_bf16_f32 v99, v48, v49
    v_pk_add_f32 v[50:51], v[50:51], v[94:95] neg_lo:[0,1] neg_hi:[0,1]
    v_cvt_pk_bf16_f32 v100, v50, v51
    v_pk_add_f32 v[52:53], v[52:53], v[94:95] neg_lo:[0,1] neg_hi:[0,1]
    v_cvt_pk_bf16_f32 v101, v52, v53
    v_pk_add_f32 v[54:55], v[54:55], v[94:95] neg_lo:[0,1] neg_hi:[0,1]
    v_cvt_pk_bf16_f32 v102, v54, v55
    v_pk_add_f32 v[56:57], v[56:57], v[94:95] neg_lo:[0,1] neg_hi:[0,1]
    v_cvt_pk_bf16_f32 v103, v56, v57
    v_pk_add_f32 v[58:59], v[58:59], v[94:95] neg_lo:[0,1] neg_hi:[0,1]
    v_cvt_pk_bf16_f32 v104, v58, v59
    v_pk_add_f32 v[60:61], v[60:61], v[94:95] neg_lo:[0,1] neg_hi:[0,1]
    v_cvt_pk_bf16_f32 v105, v60, v61
    v_pk_add_f32 v[62:63], v[62:63], v[94:95] neg_lo:[0,1] neg_hi:[0,1]
    v_cvt_pk_bf16_f32 v106, v62, v63
    v_pk_add_f32 v[64:65], v[64:65], v[94:95] neg_lo:[0,1] neg_hi:[0,1]
    v_cvt_pk_bf16_f32 v107, v64, v65
    v_lshlrev_b32 v46, 16, v98
    v_and_b32 v47, s15, v98
    v_pk_mul_f32 v[46:47], v[46:47], v[90:91]
    v_cvt_pk_bf16_f32 v98, v46, v47
    v_lshlrev_b32 v48, 16, v99
    v_and_b32 v49, s15, v99
    v_pk_mul_f32 v[48:49], v[48:49], v[90:91]
    v_cvt_pk_bf16_f32 v99, v48, v49
    v_lshlrev_b32 v50, 16, v100
    v_and_b32 v51, s15, v100
    v_pk_mul_f32 v[50:51], v[50:51], v[90:91]
    v_cvt_pk_bf16_f32 v100, v50, v51
    v_lshlrev_b32 v52, 16, v101
    v_and_b32 v53, s15, v101
    v_pk_mul_f32 v[52:53], v[52:53], v[90:91]
    v_cvt_pk_bf16_f32 v101, v52, v53
    v_lshlrev_b32 v54, 16, v102
    v_and_b32 v55, s15, v102
    v_pk_mul_f32 v[54:55], v[54:55], v[90:91]
    v_cvt_pk_bf16_f32 v102, v54, v55
    v_lshlrev_b32 v56, 16, v103
    v_and_b32 v57, s15, v103
    v_pk_mul_f32 v[56:57], v[56:57], v[90:91]
    v_cvt_pk_bf16_f32 v103, v56, v57
    v_lshlrev_b32 v58, 16, v104
    v_and_b32 v59, s15, v104
    v_pk_mul_f32 v[58:59], v[58:59], v[90:91]
    v_cvt_pk_bf16_f32 v104, v58, v59
    v_lshlrev_b32 v60, 16, v105
    v_and_b32 v61, s15, v105
    v_pk_mul_f32 v[60:61], v[60:61], v[90:91]
    v_cvt_pk_bf16_f32 v105, v60, v61
    v_lshlrev_b32 v62, 16, v106
    v_and_b32 v63, s15, v106
    v_pk_mul_f32 v[62:63], v[62:63], v[90:91]
    v_cvt_pk_bf16_f32 v106, v62, v63
    v_lshlrev_b32 v64, 16, v107
    v_and_b32 v65, s15, v107
    v_pk_mul_f32 v[64:65], v[64:65], v[90:91]
    v_cvt_pk_bf16_f32 v107, v64, v65
    s_waitcnt lgkmcnt(0)
    s_add_u32 s58, s58, 1
    s_addc_u32 s59, s59, 0
    s_lshr_b64 s[82:83], s[58:59], 30
    s_xor_b32 s83, s82, 0x2b7
    s_and_b32 s83, s83, 0x3ff
    s_and_b32 s66, s58, 0x3ff
    s_bfe_u32 s67, s58, 0xa000a
    s_bfe_u32 s82, s58, 0xa0014
    s_xor_b32 s67, s67, 0x1d3
    s_xor_b32 s82, s82, 0x36c
    v_lshlrev_b32 v70, 2, v1
    v_add_u32 v70, 45232, v70
    v_lshlrev_b32 v124, 4, v0
    v_cmp_lt_u32 vcc, 159, v0
    s_nop 1
    v_cndmask_b32_e64 v125, 0, 1.0, vcc
    s_mov_b32 s16, 15360
    s_mov_b32 s17, 30720
    s_mov_b32 s18, 46080
    s_waitcnt lgkmcnt(0)
    s_barrier
    s_mov_b32 s7, 0
    s_nop 1
Lp1:
    buffer_load_dwordx4 v[108:111], v124, s[24:27], 0 offen sc1
    buffer_load_dwordx4 v[112:115], v124, s[24:27], s16 offen sc1
    buffer_load_dwordx4 v[116:119], v124, s[24:27], s17 offen sc1
    buffer_load_dwordx4 v[120:123], v124, s[24:27], s18 offen sc1
    s_add_u32 s7, s7, 1
    s_waitcnt vmcnt(3)
    v_xor_b32 v15, s66, v108
    v_bitop3_b32 v15, v109, s67, v15 bitop3:0xbe
    v_bitop3_b32 v15, v110, s82, v15 bitop3:0xbe
    v_bitop3_b32 v15, v111, s83, v15 bitop3:0xbe
    s_waitcnt vmcnt(2)
    v_bitop3_b32 v15, v112, s66, v15 bitop3:0xbe
    v_bitop3_b32 v15, v113, s67, v15 bitop3:0xbe
    v_bitop3_b32 v15, v114, s82, v15 bitop3:0xbe
    v_bitop3_b32 v15, v115, s83, v15 bitop3:0xbe
    s_waitcnt vmcnt(1)
    v_bitop3_b32 v15, v116, s66, v15 bitop3:0xbe
    v_bitop3_b32 v15, v117, s67, v15 bitop3:0xbe
    v_bitop3_b32 v15, v118, s82, v15 bitop3:0xbe
    v_bitop3_b32 v15, v119, s83, v15 bitop3:0xbe
    s_waitcnt vmcnt(0)
    v_bitop3_b32 v15, v120, s66, v15 bitop3:0xbe
    v_bitop3_b32 v15, v121, s67, v15 bitop3:0xbe
    v_bitop3_b32 v15, v122, s82, v15 bitop3:0xbe
    v_bitop3_b32 v15, v123, s83, v15 bitop3:0xbe
    v_and_b32 v15, v31, v15
    v_cmp_ne_u32 vcc, 0, v15
    s_cmp_ge_u32 s7, 20000
    s_cbranch_scc1 Lp2
    s_and_b64 exec, exec, vcc
    s_cbranch_execnz Lp1
    s_nop 1
Lp2:
    s_mov_b64 exec, -1
    v_pk_add_f32 v[108:109], v[108:109], v[112:113]
    v_pk_add_f32 v[116:117], v[116:117], v[120:121]
    v_pk_add_f32 v[108:109], v[108:109], v[116:117]
    v_pk_add_f32 v[110:111], v[110:111], v[114:115]
    v_pk_add_f32 v[118:119], v[118:119], v[122:123]
    v_pk_add_f32 v[110:111], v[110:111], v[118:119]
    v_cvt_pk_bf16_f32 v112, v108, v109
    v_lshlrev_b32 v108, 16, v112
    v_and_b32 v109, s15, v112
    v_cvt_pk_bf16_f32 v114, v110, v111
    v_lshlrev_b32 v110, 16, v114
    v_and_b32 v111, s15, v114
    v_add_f32 v108, v125, v108
    v_add_f32 v109, v125, v109
    v_add_f32 v110, v125, v110
    v_add_f32 v111, v125, v111
    v_cvt_pk_bf16_f32 v112, v108, v109
    v_lshlrev_b32 v108, 16, v112
    v_and_b32 v109, s15, v112
    v_cvt_pk_bf16_f32 v114, v110, v111
    v_lshlrev_b32 v110, 16, v114
    v_and_b32 v111, s15, v114
    ds_write_b128 v124, v[108:111] offset:45232
    s_waitcnt lgkmcnt(0)
    s_barrier
    ds_read2st64_b32 v[88:89], v70 offset0:10 offset1:0
    ds_read2st64_b32 v[90:91], v70 offset0:11 offset1:1
    ds_read2st64_b32 v[96:97], v70 offset0:12 offset1:2
    ds_read2st64_b32 v[94:95], v70 offset0:13 offset1:3
    ds_read2st64_b32 v[92:93], v70 offset0:14 offset1:4
    ds_read2st64_b32 v[108:109], v70 offset0:15 offset1:5
    ds_read2st64_b32 v[110:111], v70 offset0:16 offset1:6
    ds_read2st64_b32 v[112:113], v70 offset0:17 offset1:7
    ds_read2st64_b32 v[114:115], v70 offset0:18 offset1:8
    ds_read2st64_b32 v[116:117], v70 offset0:19 offset1:9
    s_waitcnt lgkmcnt(9)
    v_lshrrev_b32 v118, 16, v88
    s_waitcnt lgkmcnt(8)
    v_lshrrev_b32 v119, 16, v90
    s_waitcnt lgkmcnt(7)
    v_lshrrev_b32 v120, 16, v96
    s_waitcnt lgkmcnt(6)
    v_lshrrev_b32 v121, 16, v94
    s_waitcnt lgkmcnt(5)
    v_lshrrev_b32 v122, 16, v92
    s_waitcnt lgkmcnt(4)
    v_lshrrev_b32 v123, 16, v108
    s_waitcnt lgkmcnt(3)
    v_lshrrev_b32 v124, 16, v110
    s_waitcnt lgkmcnt(2)
    v_lshrrev_b32 v125, 16, v112
    s_waitcnt lgkmcnt(1)
    v_lshrrev_b32 v126, 16, v114
    s_waitcnt lgkmcnt(0)
    v_lshrrev_b32 v127, 16, v116
    v_dot2_f32_bf16 v46, v98, v118, 0
    v_dot2_f32_bf16 v47, v98, v88, 0
    v_dot2_f32_bf16 v48, v99, v119, 0
    v_dot2_f32_bf16 v49, v99, v90, 0
    v_dot2_f32_bf16 v50, v100, v120, 0
    v_dot2_f32_bf16 v51, v100, v96, 0
    v_dot2_f32_bf16 v52, v101, v121, 0
    v_dot2_f32_bf16 v53, v101, v94, 0
    v_dot2_f32_bf16 v54, v102, v122, 0
    v_dot2_f32_bf16 v55, v102, v92, 0
    v_dot2_f32_bf16 v56, v103, v123, 0
    v_dot2_f32_bf16 v57, v103, v108, 0
    v_dot2_f32_bf16 v58, v104, v124, 0
    v_dot2_f32_bf16 v59, v104, v110, 0
    v_dot2_f32_bf16 v60, v105, v125, 0
    v_dot2_f32_bf16 v61, v105, v112, 0
    v_dot2_f32_bf16 v62, v106, v126, 0
    v_dot2_f32_bf16 v63, v106, v114, 0
    v_dot2_f32_bf16 v64, v107, v127, 0
    v_dot2_f32_bf16 v65, v107, v116, 0
    v_cvt_pk_bf16_f32 v98, v46, v47
    v_cvt_pk_bf16_f32 v99, v48, v49
    v_cvt_pk_bf16_f32 v100, v50, v51
    v_cvt_pk_bf16_f32 v101, v52, v53
    v_cvt_pk_bf16_f32 v102, v54, v55
    v_cvt_pk_bf16_f32 v103, v56, v57
    v_cvt_pk_bf16_f32 v104, v58, v59
    v_cvt_pk_bf16_f32 v105, v60, v61
    v_cvt_pk_bf16_f32 v106, v62, v63
    v_cvt_pk_bf16_f32 v107, v64, v65
    v_dot2_f32_bf16 v46, v98, s44, v89
    v_dot2_f32_bf16 v47, v98, s45, v89
    v_dot2_f32_bf16 v48, v99, s44, v91
    v_dot2_f32_bf16 v49, v99, s45, v91
    v_dot2_f32_bf16 v50, v100, s44, v97
    v_dot2_f32_bf16 v51, v100, s45, v97
    v_dot2_f32_bf16 v52, v101, s44, v95
    v_dot2_f32_bf16 v53, v101, s45, v95
    v_dot2_f32_bf16 v54, v102, s44, v93
    v_dot2_f32_bf16 v55, v102, s45, v93
    v_dot2_f32_bf16 v56, v103, s44, v109
    v_dot2_f32_bf16 v57, v103, s45, v109
    v_dot2_f32_bf16 v58, v104, s44, v111
    v_dot2_f32_bf16 v59, v104, s45, v111
    v_dot2_f32_bf16 v60, v105, s44, v113
    v_dot2_f32_bf16 v61, v105, s45, v113
    v_dot2_f32_bf16 v62, v106, s44, v115
    v_dot2_f32_bf16 v63, v106, s45, v115
    v_dot2_f32_bf16 v64, v107, s44, v117
    v_dot2_f32_bf16 v65, v107, s45, v117
    v_cvt_pk_bf16_f32 v98, v46, v47
    v_cvt_pk_bf16_f32 v99, v48, v49
    v_cvt_pk_bf16_f32 v100, v50, v51
    v_cvt_pk_bf16_f32 v101, v52, v53
    v_cvt_pk_bf16_f32 v102, v54, v55
    v_cvt_pk_bf16_f32 v103, v56, v57
    v_cvt_pk_bf16_f32 v104, v58, v59
    v_cvt_pk_bf16_f32 v105, v60, v61
    v_cvt_pk_bf16_f32 v106, v62, v63
    v_cvt_pk_bf16_f32 v107, v64, v65
    v_lshlrev_b32 v46, 16, v98
    v_and_b32 v47, s15, v98
    v_lshlrev_b32 v48, 16, v99
    v_and_b32 v49, s15, v99
    v_lshlrev_b32 v50, 16, v100
    v_and_b32 v51, s15, v100
    v_lshlrev_b32 v52, 16, v101
    v_and_b32 v53, s15, v101
    v_lshlrev_b32 v54, 16, v102
    v_and_b32 v55, s15, v102
    v_lshlrev_b32 v56, 16, v103
    v_and_b32 v57, s15, v103
    v_lshlrev_b32 v58, 16, v104
    v_and_b32 v59, s15, v104
    v_lshlrev_b32 v60, 16, v105
    v_and_b32 v61, s15, v105
    v_lshlrev_b32 v62, 16, v106
    v_and_b32 v63, s15, v106
    v_lshlrev_b32 v64, 16, v107
    v_and_b32 v65, s15, v107
    v_pk_add_f32 v[116:117], v[46:47], v[56:57]
    v_pk_add_f32 v[114:115], v[46:47], v[56:57] neg_lo:[0,1] neg_hi:[0,1]
    v_pk_add_f32 v[56:57], v[50:51], v[60:61]
    v_pk_add_f32 v[46:47], v[50:51], v[60:61] neg_lo:[0,1] neg_hi:[0,1]
    v_pk_add_f32 v[60:61], v[54:55], v[64:65]
    v_pk_add_f32 v[50:51], v[54:55], v[64:65] neg_lo:[0,1] neg_hi:[0,1]
    v_pk_add_f32 v[64:65], v[58:59], v[48:49]
    v_pk_add_f32 v[54:55], v[58:59], v[48:49] neg_lo:[0,1] neg_hi:[0,1]
    v_pk_add_f32 v[48:49], v[62:63], v[52:53]
    v_pk_add_f32 v[58:59], v[62:63], v[52:53] neg_lo:[0,1] neg_hi:[0,1]
    v_pk_add_f32 v[52:53], v[56:57], v[48:49]
    v_pk_add_f32 v[62:63], v[60:61], v[64:65]
    v_pk_add_f32 v[112:113], v[56:57], v[48:49] neg_lo:[0,1] neg_hi:[0,1]
    v_pk_add_f32 v[110:111], v[60:61], v[64:65] neg_lo:[0,1] neg_hi:[0,1]
    v_pk_add_f32 v[48:49], v[52:53], v[62:63]
    v_pk_add_f32 v[64:65], v[116:117], v[48:49]
    v_pk_fma_f32 v[48:49], v[52:53], s[34:35], v[116:117]
    v_pk_fma_f32 v[48:49], v[62:63], s[36:37], v[48:49]
    v_pk_fma_f32 v[60:61], v[52:53], s[36:37], v[116:117]
    v_pk_fma_f32 v[60:61], v[62:63], s[34:35], v[60:61]
    v_pk_mul_f32 v[62:63], v[112:113], s[38:39]
    v_pk_fma_f32 v[62:63], v[110:111], s[40:41], v[62:63]
    v_pk_mul_f32 v[52:53], v[112:113], s[40:41]
    v_pk_fma_f32 v[52:53], v[110:111], s[38:39], v[52:53] neg_lo:[1,0,0] neg_hi:[1,0,0]
    v_pk_add_f32 v[110:111], v[48:49], v[62:63] op_sel:[0,1] op_sel_hi:[1,0] neg_hi:[0,1]
    v_pk_add_f32 v[112:113], v[48:49], v[62:63] op_sel:[0,1] op_sel_hi:[1,0] neg_lo:[0,1]
    v_pk_add_f32 v[116:117], v[60:61], v[52:53] op_sel:[0,1] op_sel_hi:[1,0] neg_hi:[0,1]
    v_pk_add_f32 v[56:57], v[60:61], v[52:53] op_sel:[0,1] op_sel_hi:[1,0] neg_lo:[0,1]
    v_pk_add_f32 v[52:53], v[46:47], v[58:59]
    v_pk_add_f32 v[62:63], v[50:51], v[54:55]
    v_pk_add_f32 v[60:61], v[46:47], v[58:59] neg_lo:[0,1] neg_hi:[0,1]
    v_pk_add_f32 v[48:49], v[50:51], v[54:55] neg_lo:[0,1] neg_hi:[0,1]
    v_pk_add_f32 v[58:59], v[52:53], v[62:63]
    v_pk_add_f32 v[54:55], v[114:115], v[58:59]
    v_pk_fma_f32 v[58:59], v[52:53], s[34:35], v[114:115]
    v_pk_fma_f32 v[58:59], v[62:63], s[36:37], v[58:59]
    v_pk_fma_f32 v[50:51], v[52:53], s[36:37], v[114:115]
    v_pk_fma_f32 v[50:51], v[62:63], s[34:35], v[50:51]
    v_pk_mul_f32 v[62:63], v[60:61], s[38:39]
    v_pk_fma_f32 v[62:63], v[48:49], s[40:41], v[62:63]
    v_pk_mul_f32 v[52:53], v[60:61], s[40:41]
    v_pk_fma_f32 v[52:53], v[48:49], s[38:39], v[52:53] neg_lo:[1,0,0] neg_hi:[1,0,0]
    v_pk_add_f32 v[48:49], v[58:59], v[62:63] op_sel:[0,1] op_sel_hi:[1,0] neg_hi:[0,1]
    v_pk_add_f32 v[60:61], v[58:59], v[62:63] op_sel:[0,1] op_sel_hi:[1,0] neg_lo:[0,1]
    v_pk_add_f32 v[114:115], v[50:51], v[52:53] op_sel:[0,1] op_sel_hi:[1,0] neg_hi:[0,1]
    v_pk_add_f32 v[46:47], v[50:51], v[52:53] op_sel:[0,1] op_sel_hi:[1,0] neg_lo:[0,1]
    ds_write_b64 v2, v[64:65] offset:0
    v_pk_mul_f32 v[52:53], v[48:49], v[68:69] op_sel:[0,0] op_sel_hi:[1,0]
    v_pk_fma_f32 v[48:49], v[48:49], v[68:69], v[52:53] op_sel:[1,1,0] op_sel_hi:[0,1,1] neg_hi:[1,0,0]
    ds_write_b64 v2, v[48:49] offset:2432
    v_pk_mul_f32 v[52:53], v[116:117], v[72:73] op_sel:[0,0] op_sel_hi:[1,0]
    v_pk_fma_f32 v[116:117], v[116:117], v[72:73], v[52:53] op_sel:[1,1,0] op_sel_hi:[0,1,1] neg_hi:[1,0,0]
    ds_write_b64 v2, v[116:117] offset:4864
    v_pk_mul_f32 v[52:53], v[46:47], v[74:75] op_sel:[0,0] op_sel_hi:[1,0]
    v_pk_fma_f32 v[46:47], v[46:47], v[74:75], v[52:53] op_sel:[1,1,0] op_sel_hi:[0,1,1] neg_hi:[1,0,0]
    ds_write_b64 v2, v[46:47] offset:7296
    v_pk_mul_f32 v[52:53], v[112:113], v[76:77] op_sel:[0,0] op_sel_hi:[1,0]
    v_pk_fma_f32 v[112:113], v[112:113], v[76:77], v[52:53] op_sel:[1,1,0] op_sel_hi:[0,1,1] neg_hi:[1,0,0]
    ds_write_b64 v2, v[112:113] offset:9728
    v_pk_mul_f32 v[52:53], v[54:55], v[78:79] op_sel:[0,0] op_sel_hi:[1,0]
    v_pk_fma_f32 v[54:55], v[54:55], v[78:79], v[52:53] op_sel:[1,1,0] op_sel_hi:[0,1,1] neg_hi:[1,0,0]
    ds_write_b64 v2, v[54:55] offset:12160
    v_pk_mul_f32 v[52:53], v[110:111], v[80:81] op_sel:[0,0] op_sel_hi:[1,0]
    v_pk_fma_f32 v[110:111], v[110:111], v[80:81], v[52:53] op_sel:[1,1,0] op_sel_hi:[0,1,1] neg_hi:[1,0,0]
    ds_write_b64 v2, v[110:111] offset:14592
    v_pk_mul_f32 v[52:53], v[114:115], v[82:83] op_sel:[0,0] op_sel_hi:[1,0]
    v_pk_fma_f32 v[114:115], v[114:115], v[82:83], v[52:53] op_sel:[1,1,0] op_sel_hi:[0,1,1] neg_hi:[1,0,0]
    ds_write_b64 v2, v[114:115] offset:17024
    v_pk_mul_f32 v[52:53], v[56:57], v[84:85] op_sel:[0,0] op_sel_hi:[1,0]
    v_pk_fma_f32 v[56:57], v[56:57], v[84:85], v[52:53] op_sel:[1,1,0] op_sel_hi:[0,1,1] neg_hi:[1,0,0]
    ds_write_b64 v2, v[56:57] offset:19456
    v_pk_mul_f32 v[52:53], v[60:61], v[86:87] op_sel:[0,0] op_sel_hi:[1,0]
    v_pk_fma_f32 v[60:61], v[60:61], v[86:87], v[52:53] op_sel:[1,1,0] op_sel_hi:[0,1,1] neg_hi:[1,0,0]
    ds_write_b64 v2, v[60:61] offset:21888
    s_branch L_pass2
    s_nop 1
L_w4:
    s_waitcnt lgkmcnt(0)
    s_load_dwordx2 s[58:59], s[84:85], 61440
    s_mov_b32 s32, 0x3f3504f3
    s_mov_b32 s33, 0x3f3504f3
    s_mov_b32 s34, 0x3e9e377a
    s_mov_b32 s35, 0x3e9e377a
    s_mov_b32 s36, 0xbf4f1bbd
    s_mov_b32 s37, 0xbf4f1bbd
    s_mov_b32 s38, 0x3f737871
    s_mov_b32 s39, 0x3f737871
    s_mov_b32 s40, 0x3f167918
    s_mov_b32 s41, 0x3f167918
    s_mov_b32 s42, 0x34cccccd
    s_mov_b32 s43, 0x34cccccd
    s_movk_i32 s44, 0x3f80
    s_mov_b32 s45, 1.0
    v_and_b32 v2, 7, v0
    s_lshl_b32 s14, s3, 3
    v_add_u32 v15, s14, v2
    v_lshrrev_b32 v14, 3, v1
    v_mul_u32_u24 v3, 608, v15
    v_mul_u32_u24 v4, 72, v14
    v_add_u32 v4, v4, v3
    v_lshl_add_u32 v3, v14, 3, v3
    v_lshrrev_b32 v5, 3, v15
    v_mul_u32_u24 v6, 5, v14
    v_add_u32 v5, v5, v6
    v_bfe_u32 v64, v15, 2, 1
    v_sub_u32 v6, 40, v5
    v_sub_u32 v6, v6, v64
    v_mul_u32_u24 v64, 2576, v64
    v_and_b32 v15, 3, v15
    v_mul_u32_u24 v9, 5152, v15
    v_add3_u32 v9, v9, v64, 0
    v_add_u32 v9, 24320, v9
    v_and_b32 v15, 1, v15
    v_lshlrev_b32 v15, 3, v15
    v_lshl_add_u32 v5, v5, 4, v9
    v_add_u32 v5, v5, v15
    v_lshl_add_u32 v6, v6, 4, v9
    v_xor_b32 v15, 8, v15
    v_add_u32 v6, v6, v15
    s_mul_i32 s14, s3, 4608
    s_add_u32 s14, s14, 24320
    v_lshlrev_b32 v11, 3, v1
    v_add_u32 v11, s14, v11
    v_mul_u32_u24 v12, 576, v14
    v_add_u32 v12, s14, v12
    v_mul_u32_u24 v13, 72, v2
    v_add_u32 v13, v13, v12
    v_lshl_add_u32 v12, v2, 3, v12
    v_mul_u32_u24 v15, 0x3334, v0
    v_lshrrev_b32 v15, 16, v15
    v_mul_u32_u24 v10, 5, v15
    v_sub_u32 v10, v0, v10
    v_mul_u32_u24 v8, 20608, v15
    v_lshl_add_u32 v8, v10, 4, v8
    v_mul_u32_u24 v29, 80, v15
    v_lshl_add_u32 v29, v10, 4, v29
    v_mul_u32_u24 v9, 4112, v10
    v_lshl_add_u32 v9, v15, 4, v9
    s_mul_i32 s14, s3, 4112
    v_lshlrev_b32 v10, 4, v1
    v_add_u32 v10, s14, v10
    s_mul_i32 s14, s3, 608
    v_lshlrev_b32 v2, 3, v1
    v_add_u32 v2, s14, v2
    s_lshl_b32 s14, s3, 5
    v_and_b32 v64, 31, v1
    v_add_u32 v64, s14, v64
    v_lshrrev_b32 v65, 5, v1
    v_mul_u32_u24 v26, 2576, v65
    v_lshl_add_u32 v26, v64, 4, v26
    v_mul_u32_u24 v27, 2560, v65
    v_lshl_add_u32 v27, v64, 4, v27
    v_mul_u32_u24 v15, 0x3334, v64
    v_lshrrev_b32 v15, 16, v15
    v_mul_u32_u24 v28, 20528, v15
    v_lshl_add_u32 v28, v64, 4, v28
    v_mul_u32_u24 v15, 659456, v65
    v_add_u32 v28, v28, v15
    s_cmp_eq_u32 s3, 0
    s_cselect_b32 s86, 1, 0
    s_cselect_b32 s12, 15, 0
    s_mov_b32 s87, 0
    s_mov_b32 s13, 0
    v_mul_u32_u24 v15, s4, v1
    v_cvt_f32_u32 v15, v15
    v_mul_f32 v15, 0x3a000000, v15
    v_fract_f32 v15, v15
    v_cos_f32 v64, v15
    v_sin_f32 v65, v15
    v_readlane_b32 s46, v64, 1
    v_readlane_b32 s47, v65, 1
    v_readlane_b32 s48, v64, 2
    v_readlane_b32 s49, v65, 2
    v_readlane_b32 s50, v64, 3
    v_readlane_b32 s51, v65, 3
    v_readlane_b32 s52, v64, 4
    v_readlane_b32 s53, v65, 4
    v_readlane_b32 s54, v64, 5
    v_readlane_b32 s55, v65, 5
    v_readlane_b32 s56, v64, 6
    v_readlane_b32 s57, v65, 6
    v_readlane_b32 s70, v64, 7
    v_readlane_b32 s71, v65, 7
    v_mul_u32_u24 v15, 1, v14
    v_cvt_f32_u32 v15, v15
    v_mul_f32 v15, 0x3c800000, v15
    v_fract_f32 v15, v15
    v_cos_f32 v32, v15
    v_sin_f32 v33, v15
    v_mul_u32_u24 v15, 2, v14
    v_cvt_f32_u32 v15, v15
    v_mul_f32 v15, 0x3c800000, v15
    v_fract_f32 v15, v15
    v_cos_f32 v34, v15
    v_sin_f32 v35, v15
    v_mul_u32_u24 v15, 3, v14
    v_cvt_f32_u32 v15, v15
    v_mul_f32 v15, 0x3c800000, v15
    v_fract_f32 v15, v15
    v_cos_f32 v36, v15
    v_sin_f32 v37, v15
    v_mul_u32_u24 v15, 4, v14
    v_cvt_f32_u32 v15, v15
    v_mul_f32 v15, 0x3c800000, v15
    v_fract_f32 v15, v15
    v_cos_f32 v38, v15
    v_sin_f32 v39, v15
    v_mul_u32_u24 v15, 5, v14
    v_cvt_f32_u32 v15, v15
    v_mul_f32 v15, 0x3c800000, v15
    v_fract_f32 v15, v15
    v_cos_f32 v40, v15
    v_sin_f32 v41, v15
    v_mul_u32_u24 v15, 6, v14
    v_cvt_f32_u32 v15, v15
    v_mul_f32 v15, 0x3c800000, v15
    v_fract_f32 v15, v15
    v_cos_f32 v42, v15
    v_sin_f32 v43, v15
    v_mul_u32_u24 v15, 7, v14
    v_cvt_f32_u32 v15, v15
    v_mul_f32 v15, 0x3c800000, v15
    v_fract_f32 v15, v15
    v_cos_f32 v44, v15
    v_sin_f32 v45, v15
    s_mov_b32 s24, s84
    s_mov_b32 s25, s85
    s_mov_b32 s26, 0x50000
    s_mov_b32 s27, 0x00020000
    v_bfe_u32 v47, v1, 1, 3
    v_lshrrev_b32 v46, 4, v1
    v_lshl_add_u32 v46, v47, 2, v46
    v_mul_u32_u24 v46, 5136, v46
    v_and_b32 v47, 1, v1
    v_lshl_add_u32 v46, v47, 4, v46
    s_mul_i32 s8, s6, 642
    s_mul_i32 s9, s5, 20
    s_add_u32 s8, s8, s9
    s_andn2_b32 s8, s8, 3
    s_mov_b32 s16, s62
    s_mov_b32 s17, s63
    s_mov_b32 s18, 0x141000
    s_mov_b32 s19, 0x00020000
    s_mov_b32 s20, s64
    s_mov_b32 s21, s65
    s_mov_b32 s22, 0x141000
    s_mov_b32 s23, 0x00020000
    s_waitcnt lgkmcnt(0)
    s_add_u32 s58, s58, 1
    s_addc_u32 s59, s59, 0
    s_lshr_b64 s[82:83], s[58:59], 30
    s_xor_b32 s83, s82, 0x2b7
    s_and_b32 s83, s83, 0x3ff
    s_and_b32 s66, s58, 0x3ff
    s_bfe_u32 s67, s58, 0xa000a
    s_bfe_u32 s82, s58, 0xa0014
    s_xor_b32 s67, s67, 0x1d3
    s_xor_b32 s82, s82, 0x36c
    s_waitcnt lgkmcnt(0)
    s_barrier
    s_mov_b32 m0, 130736
    s_add_u32 s9, s8, 0
    buffer_load_dwordx4 v46, s[16:19], s9 offen lds
    s_mov_b32 m0, 138928
    s_add_u32 s9, s8, 0
    buffer_load_dwordx4 v46, s[20:23], s9 offen lds
    s_mov_b32 m0, 131760
    s_add_u32 s9, s8, 164352
    buffer_load_dwordx4 v46, s[16:19], s9 offen lds
    s_mov_b32 m0, 139952
    s_add_u32 s9, s8, 164352
    buffer_load_dwordx4 v46, s[20:23], s9 offen lds
    s_mov_b32 m0, 132784
    s_add_u32 s9, s8, 328704
    buffer_load_dwordx4 v46, s[16:19], s9 offen lds
    s_mov_b32 m0, 140976
    s_add_u32 s9, s8, 328704
    buffer_load_dwordx4 v46, s[20:23], s9 offen lds
    s_mov_b32 m0, 133808
    s_add_u32 s9, s8, 493056
    buffer_load_dwordx4 v46, s[16:19], s9 offen lds
    s_mov_b32 m0, 142000
    s_add_u32 s9, s8, 493056
    buffer_load_dwordx4 v46, s[20:23], s9 offen lds
    s_mov_b32 m0, 134832
    s_add_u32 s9, s8, 657408
    buffer_load_dwordx4 v46, s[16:19], s9 offen lds
    s_mov_b32 m0, 143024
    s_add_u32 s9, s8, 657408
    buffer_load_dwordx4 v46, s[20:23], s9 offen lds
    s_mov_b32 m0, 135856
    s_add_u32 s9, s8, 821760
    buffer_load_dwordx4 v46, s[16:19], s9 offen lds
    s_mov_b32 m0, 144048
    s_add_u32 s9, s8, 821760
    buffer_load_dwordx4 v46, s[20:23], s9 offen lds
    s_mov_b32 m0, 136880
    s_add_u32 s9, s8, 986112
    buffer_load_dwordx4 v46, s[16:19], s9 offen lds
    s_mov_b32 m0, 145072
    s_add_u32 s9, s8, 986112
    buffer_load_dwordx4 v46, s[20:23], s9 offen lds
    s_mov_b32 m0, 137904
    s_add_u32 s9, s8, 1150464
    buffer_load_dwordx4 v46, s[16:19], s9 offen lds
    s_mov_b32 m0, 146096
    s_add_u32 s9, s8, 1150464
    buffer_load_dwordx4 v46, s[20:23], s9 offen lds
    s_waitcnt vmcnt(6)
    s_waitcnt lgkmcnt(0)
    s_barrier
    s_waitcnt lgkmcnt(0)
    s_barrier
    s_waitcnt vmcnt(0)
    s_cmp_eq_u32 s5, 0
    s_cbranch_scc1 Lc4
    s_cmp_lg_u32 s5, 31
    s_cbranch_scc1 Lc5
    s_nop 1
Lc4:
    s_and_b32 s8, s6, 1
    s_lshl_b32 s8, s8, 1
    s_cmp_eq_u32 s5, 0
    s_cselect_b32 s9, 0, 20
    s_cselect_b32 s10, 0, 8
    s_add_u32 s8, s8, s9
    s_add_u32 s8, s8, 130736
    v_and_b32 v46, 31, v1
    v_lshlrev_b32 v46, 5, v46
    v_lshrrev_b32 v47, 5, v1
    v_lshl_add_u32 v46, v47, 12, v46
    v_add_u32 v46, s8, v46
    ds_read_u16 v48, v46 offset:0
    ds_read_u16 v52, v46 offset:8192
    ds_read_u16 v49, v46 offset:1024
    ds_read_u16 v53, v46 offset:9216
    ds_read_u16 v50, v46 offset:2048
    ds_read_u16 v54, v46 offset:10240
    ds_read_u16 v51, v46 offset:3072
    ds_read_u16 v55, v46 offset:11264
    s_add_u32 s10, s10, s6
    s_lshl_b32 s10, s10, 11
    s_add_u32 s10, s10, 65536
    v_lshlrev_b32 v47, 4, v1
    v_mov_b32 v56, s58
    v_mov_b32 v57, s59
    v_mov_b32 v60, s58
    v_mov_b32 v61, s59
    s_waitcnt lgkmcnt(0)
    v_lshl_or_b32 v58, v52, 16, v48
    v_lshl_or_b32 v59, v53, 16, v49
    v_lshl_or_b32 v62, v54, 16, v50
    v_lshl_or_b32 v63, v55, 16, v51
    buffer_store_dwordx4 v[56:59], v47, s[24:27], s10 offen offset:0 sc1
    buffer_store_dwordx4 v[60:63], v47, s[24:27], s10 offen offset:1024 sc1
    s_nop 1
Lc5:
    s_nop 1
L_pass2:
    s_setprio 3
    s_waitcnt lgkmcnt(0)
    s_barrier
    ds_read_b64 v[46:47], v3 offset:0
    ds_read_b64 v[54:55], v3 offset:256
    ds_read_b64 v[48:49], v3 offset:64
    ds_read_b64 v[56:57], v3 offset:320
    ds_read_b64 v[50:51], v3 offset:128
    ds_read_b64 v[58:59], v3 offset:384
    ds_read_b64 v[52:53], v3 offset:192
    ds_read_b64 v[60:61], v3 offset:448
    s_waitcnt lgkmcnt(6)
    v_pk_add_f32 v[62:63], v[46:47], v[54:55]
    v_pk_add_f32 v[64:65], v[46:47], v[54:55] neg_lo:[0,1] neg_hi:[0,1]
    s_waitcnt lgkmcnt(4)
    v_pk_add_f32 v[66:67], v[48:49], v[56:57]
    v_pk_add_f32 v[68:69], v[48:49], v[56:57] neg_lo:[0,1] neg_hi:[0,1]
    s_waitcnt lgkmcnt(2)
    v_pk_add_f32 v[70:71], v[50:51], v[58:59]
    v_pk_add_f32 v[72:73], v[50:51], v[58:59] neg_lo:[0,1] neg_hi:[0,1]
    s_waitcnt lgkmcnt(0)
    v_pk_add_f32 v[74:75], v[52:53], v[60:61]
    v_pk_add_f32 v[76:77], v[52:53], v[60:61] neg_lo:[0,1] neg_hi:[0,1]
    v_pk_add_f32 v[60:61], v[62:63], v[70:71]
    v_pk_add_f32 v[58:59], v[62:63], v[70:71] neg_lo:[0,1] neg_hi:[0,1]
    v_pk_add_f32 v[56:57], v[66:67], v[74:75]
    v_pk_add_f32 v[54:55], v[66:67], v[74:75] neg_lo:[0,1] neg_hi:[0,1]
    v_pk_add_f32 v[74:75], v[60:61], v[56:57]
    v_pk_add_f32 v[70:71], v[60:61], v[56:57] neg_lo:[0,1] neg_hi:[0,1]
    v_pk_add_f32 v[66:67], v[58:59], v[54:55] op_sel:[0,1] op_sel_hi:[1,0] neg_hi:[0,1]
    v_pk_add_f32 v[62:63], v[58:59], v[54:55] op_sel:[0,1] op_sel_hi:[1,0] neg_lo:[0,1]
    v_pk_add_f32 v[54:55], v[68:69], v[68:69] op_sel:[0,1] op_sel_hi:[1,0] neg_hi:[0,1]
    v_pk_add_f32 v[56:57], v[76:77], v[76:77] op_sel:[0,1] op_sel_hi:[1,0] neg_lo:[1,0] neg_hi:[1,1]
    v_pk_add_f32 v[58:59], v[64:65], v[72:73] op_sel:[0,1] op_sel_hi:[1,0] neg_hi:[0,1]
    v_pk_add_f32 v[60:61], v[64:65], v[72:73] op_sel:[0,1] op_sel_hi:[1,0] neg_lo:[0,1]
    v_pk_add_f32 v[76:77], v[54:55], v[56:57]
    v_pk_add_f32 v[72:73], v[54:55], v[56:57] neg_lo:[0,1] neg_hi:[0,1]
    v_pk_fma_f32 v[56:57], v[76:77], s[32:33], v[58:59]
    v_pk_fma_f32 v[54:55], v[76:77], s[32:33], v[58:59] neg_lo:[1,0,0] neg_hi:[1,0,0]
    v_pk_fma_f32 v[68:69], v[72:73], s[32:33], v[60:61] op_sel:[1,0,0] op_sel_hi:[0,1,1] neg_hi:[1,0,0]
    v_pk_fma_f32 v[64:65], v[72:73], s[32:33], v[60:61] op_sel:[1,0,0] op_sel_hi:[0,1,1] neg_lo:[1,0,0]
    s_setprio 2
    ds_write_b64 v3, v[74:75] offset:0
    v_pk_mul_f32 v[72:73], v[56:57], v[32:33] op_sel:[0,0] op_sel_hi:[1,0]
    v_pk_fma_f32 v[56:57], v[56:57], v[32:33], v[72:73] op_sel:[1,1,0] op_sel_hi:[0,1,1] neg_hi:[1,0,0]
    ds_write_b64 v3, v[56:57] offset:72
    v_pk_mul_f32 v[72:73], v[66:67], v[34:35] op_sel:[0,0] op_sel_hi:[1,0]
    v_pk_fma_f32 v[66:67], v[66:67], v[34:35], v[72:73] op_sel:[1,1,0] op_sel_hi:[0,1,1] neg_hi:[1,0,0]
    ds_write_b64 v3, v[66:67] offset:144
    v_pk_mul_f32 v[72:73], v[68:69], v[36:37] op_sel:[0,0] op_sel_hi:[1,0]
    v_pk_fma_f32 v[68:69], v[68:69], v[36:37], v[72:73] op_sel:[1,1,0] op_sel_hi:[0,1,1] neg_hi:[1,0,0]
    ds_write_b64 v3, v[68:69] offset:216
    v_pk_mul_f32 v[72:73], v[70:71], v[38:39] op_sel:[0,0] op_sel_hi:[1,0]
    v_pk_fma_f32 v[70:71], v[70:71], v[38:39], v[72:73] op_sel:[1,1,0] op_sel_hi:[0,1,1] neg_hi:[1,0,0]
    ds_write_b64 v3, v[70:71] offset:288
    v_pk_mul_f32 v[72:73], v[54:55], v[40:41] op_sel:[0,0] op_sel_hi:[1,0]
    v_pk_fma_f32 v[54:55], v[54:55], v[40:41], v[72:73] op_sel:[1,1,0] op_sel_hi:[0,1,1] neg_hi:[1,0,0]
    ds_write_b64 v3, v[54:55] offset:360
    v_pk_mul_f32 v[72:73], v[62:63], v[42:43] op_sel:[0,0] op_sel_hi:[1,0]
    v_pk_fma_f32 v[62:63], v[62:63], v[42:43], v[72:73] op_sel:[1,1,0] op_sel_hi:[0,1,1] neg_hi:[1,0,0]
    ds_write_b64 v3, v[62:63] offset:432
    v_pk_mul_f32 v[72:73], v[64:65], v[44:45] op_sel:[0,0] op_sel_hi:[1,0]
    v_pk_fma_f32 v[64:65], v[64:65], v[44:45], v[72:73] op_sel:[1,1,0] op_sel_hi:[0,1,1] neg_hi:[1,0,0]
    ds_write_b64 v3, v[64:65] offset:504
    s_setprio 1
    ds_read_b64 v[64:65], v4 offset:0
    ds_read_b64 v[68:69], v4 offset:32
    ds_read_b64 v[62:63], v4 offset:8
    ds_read_b64 v[66:67], v4 offset:40
    ds_read_b64 v[54:55], v4 offset:16
    ds_read_b64 v[56:57], v4 offset:48
    ds_read_b64 v[70:71], v4 offset:24
    ds_read_b64 v[74:75], v4 offset:56
    s_waitcnt lgkmcnt(6)
    v_pk_add_f32 v[72:73], v[64:65], v[68:69]
    v_pk_add_f32 v[76:77], v[64:65], v[68:69] neg_lo:[0,1] neg_hi:[0,1]
    s_waitcnt lgkmcnt(4)
    v_pk_add_f32 v[60:61], v[62:63], v[66:67]
    v_pk_add_f32 v[58:59], v[62:63], v[66:67] neg_lo:[0,1] neg_hi:[0,1]
    s_waitcnt lgkmcnt(2)
    v_pk_add_f32 v[52:53], v[54:55], v[56:57]
    v_pk_add_f32 v[50:51], v[54:55], v[56:57] neg_lo:[0,1] neg_hi:[0,1]
    s_waitcnt lgkmcnt(0)
    v_pk_add_f32 v[48:49], v[70:71], v[74:75]
    v_pk_add_f32 v[46:47], v[70:71], v[74:75] neg_lo:[0,1] neg_hi:[0,1]
    v_pk_add_f32 v[74:75], v[72:73], v[52:53]
    v_pk_add_f32 v[56:57], v[72:73], v[52:53] neg_lo:[0,1] neg_hi:[0,1]
    v_pk_add_f32 v[66:67], v[60:61], v[48:49]
    v_pk_add_f32 v[68:69], v[60:61], v[48:49] neg_lo:[0,1] neg_hi:[0,1]
    v_pk_add_f32 v[48:49], v[74:75], v[66:67]
    v_pk_add_f32 v[52:53], v[74:75], v[66:67] neg_lo:[0,1] neg_hi:[0,1]
    v_pk_add_f32 v[60:61], v[56:57], v[68:69] op_sel:[0,1] op_sel_hi:[1,0] neg_hi:[0,1]
    v_pk_add_f32 v[72:73], v[56:57], v[68:69] op_sel:[0,1] op_sel_hi:[1,0] neg_lo:[0,1]
    v_pk_add_f32 v[68:69], v[58:59], v[58:59] op_sel:[0,1] op_sel_hi:[1,0] neg_hi:[0,1]
    v_pk_add_f32 v[66:67], v[46:47], v[46:47] op_sel:[0,1] op_sel_hi:[1,0] neg_lo:[1,0] neg_hi:[1,1]
    v_pk_add_f32 v[56:57], v[76:77], v[50:51] op_sel:[0,1] op_sel_hi:[1,0] neg_hi:[0,1]
    v_pk_add_f32 v[74:75], v[76:77], v[50:51] op_sel:[0,1] op_sel_hi:[1,0] neg_lo:[0,1]
    v_pk_add_f32 v[46:47], v[68:69], v[66:67]
    v_pk_add_f32 v[50:51], v[68:69], v[66:67] neg_lo:[0,1] neg_hi:[0,1]
    v_pk_fma_f32 v[66:67], v[46:47], s[32:33], v[56:57]
    v_pk_fma_f32 v[68:69], v[46:47], s[32:33], v[56:57] neg_lo:[1,0,0] neg_hi:[1,0,0]
    v_pk_fma_f32 v[58:59], v[50:51], s[32:33], v[74:75] op_sel:[1,0,0] op_sel_hi:[0,1,1] neg_hi:[1,0,0]
    v_pk_fma_f32 v[76:77], v[50:51], s[32:33], v[74:75] op_sel:[1,0,0] op_sel_hi:[0,1,1] neg_lo:[1,0,0]
    s_setprio 0
    v_xor_b32 v15, 8, v5
    s_mov_b64 exec, s[12:13]
    v_pk_add_f32 v[50:51], v[48:49], v[52:53] op_sel:[0,1] op_sel_hi:[1,0] neg_hi:[0,1]
    v_pk_add_f32 v[48:49], v[48:49], v[52:53] op_sel:[0,1] op_sel_hi:[1,0] neg_lo:[0,1]
    ds_write_b64 v15, v[50:51]
    s_mov_b64 exec, -1
    ds_write_b64 v5, v[48:49] offset:0
    ds_write_b64 v5, v[66:67] offset:640
    ds_write_b64 v5, v[60:61] offset:1280
    ds_write_b64 v5, v[58:59] offset:1920
    ds_write_b64 v6, v[52:53] offset:1920
    ds_write_b64 v6, v[68:69] offset:1280
    ds_write_b64 v6, v[72:73] offset:640
    ds_write_b64 v6, v[76:77] offset:0
    s_add_u32 s20, s84, 0x100000
    s_addc_u32 s21, s85, 0
    s_mov_b32 s22, 0x508000
    s_mov_b32 s23, 0x00020000
    s_mul_i32 s8, s4, 20608
    s_add_u32 s9, s8, 5120
    s_add_u32 s10, s8, 10240
    s_add_u32 s11, s8, 15360
    s_waitcnt lgkmcnt(0)
    s_barrier
    ds_read_b128 v[80:83], v26 offset:24320
    ds_read_b128 v[88:91], v26 offset:34624
    ds_read_b128 v[84:87], v26 offset:29472
    ds_read_b128 v[92:95], v26 offset:39776
    s_waitcnt lgkmcnt(2)
    v_pk_add_f32 v[76:77], v[80:81], v[82:83] neg_hi:[0,1]
    v_pk_add_f32 v[72:73], v[80:81], v[82:83] op_sel:[1,1] op_sel_hi:[0,0] neg_hi:[1,0]
    v_pk_add_f32 v[68:69], v[88:89], v[90:91] neg_hi:[0,1]
    v_pk_add_f32 v[52:53], v[88:89], v[90:91] op_sel:[1,1] op_sel_hi:[0,0] neg_hi:[1,0]
    v_pk_add_f32 v[58:59], v[76:77], v[68:69]
    v_pk_add_f32 v[60:61], v[76:77], v[68:69] neg_lo:[0,1] neg_hi:[0,1]
    v_pk_add_f32 v[66:67], v[72:73], v[52:53]
    v_pk_add_f32 v[48:49], v[72:73], v[52:53] neg_lo:[0,1] neg_hi:[0,1]
    s_waitcnt lgkmcnt(0)
    v_pk_add_f32 v[50:51], v[86:87], v[84:85] neg_hi:[0,1]
    v_pk_add_f32 v[46:47], v[86:87], v[84:85] op_sel:[1,1] op_sel_hi:[0,0] neg_hi:[1,0]
    v_pk_add_f32 v[74:75], v[94:95], v[92:93] neg_hi:[0,1]
    v_pk_add_f32 v[56:57], v[94:95], v[92:93] op_sel:[1,1] op_sel_hi:[0,0] neg_hi:[1,0]
    v_pk_add_f32 v[70:71], v[50:51], v[74:75]
    v_pk_add_f32 v[54:55], v[50:51], v[74:75] neg_lo:[0,1] neg_hi:[0,1]
    v_pk_add_f32 v[62:63], v[46:47], v[56:57]
    v_pk_add_f32 v[64:65], v[46:47], v[56:57] neg_lo:[0,1] neg_hi:[0,1]
    v_pk_add_f32 v[56:57], v[58:59], v[70:71]
    v_pk_add_f32 v[74:75], v[58:59], v[70:71] neg_lo:[0,1] neg_hi:[0,1]
    v_pk_add_f32 v[52:53], v[66:67], v[62:63]
    v_pk_add_f32 v[68:69], v[66:67], v[62:63] neg_lo:[0,1] neg_hi:[0,1]
    v_pk_add_f32 v[62:63], v[56:57], v[52:53]
    v_pk_add_f32 v[70:71], v[56:57], v[52:53] neg_lo:[0,1] neg_hi:[0,1]
    v_pk_add_f32 v[66:67], v[74:75], v[68:69] op_sel:[0,1] op_sel_hi:[1,0] neg_hi:[0,1]
    v_pk_add_f32 v[58:59], v[74:75], v[68:69] op_sel:[0,1] op_sel_hi:[1,0] neg_lo:[0,1]
    v_pk_add_f32 v[68:69], v[48:49], v[48:49] op_sel:[0,1] op_sel_hi:[1,0] neg_hi:[0,1]
    v_pk_add_f32 v[52:53], v[64:65], v[64:65] op_sel:[0,1] op_sel_hi:[1,0] neg_lo:[1,0] neg_hi:[1,1]
    v_pk_add_f32 v[74:75], v[60:61], v[54:55] op_sel:[0,1] op_sel_hi:[1,0] neg_hi:[0,1]
    v_pk_add_f32 v[56:57], v[60:61], v[54:55] op_sel:[0,1] op_sel_hi:[1,0] neg_lo:[0,1]
    v_pk_add_f32 v[64:65], v[68:69], v[52:53]
    v_pk_add_f32 v[54:55], v[68:69], v[52:53] neg_lo:[0,1] neg_hi:[0,1]
    v_pk_fma_f32 v[52:53], v[64:65], s[32:33], v[74:75]
    v_pk_fma_f32 v[68:69], v[64:65], s[32:33], v[74:75] neg_lo:[1,0,0] neg_hi:[1,0,0]
    v_pk_fma_f32 v[48:49], v[54:55], s[32:33], v[56:57] op_sel:[1,0,0] op_sel_hi:[0,1,1] neg_hi:[1,0,0]
    v_pk_fma_f32 v[60:61], v[54:55], s[32:33], v[56:57] op_sel:[1,0,0] op_sel_hi:[0,1,1] neg_lo:[1,0,0]
    v_pk_mul_f32 v[54:55], v[68:69], s[54:55] op_sel:[0,0] op_sel_hi:[1,0]
    v_pk_fma_f32 v[90:91], v[68:69], s[54:55], v[54:55] op_sel:[1,1,0] op_sel_hi:[0,1,1] neg_hi:[1,0,0]
    v_pk_mul_f32 v[54:55], v[58:59], s[56:57] op_sel:[0,0] op_sel_hi:[1,0]
    v_pk_fma_f32 v[92:93], v[58:59], s[56:57], v[54:55] op_sel:[1,1,0] op_sel_hi:[0,1,1] neg_hi:[1,0,0]
    v_pk_mul_f32 v[54:55], v[60:61], s[70:71] op_sel:[0,0] op_sel_hi:[1,0]
    v_pk_fma_f32 v[94:95], v[60:61], s[70:71], v[54:55] op_sel:[1,1,0] op_sel_hi:[0,1,1] neg_hi:[1,0,0]
    v_pk_mul_f32 v[54:55], v[70:71], s[52:53] op_sel:[0,0] op_sel_hi:[1,0]
    v_pk_fma_f32 v[88:89], v[70:71], s[52:53], v[54:55] op_sel:[1,1,0] op_sel_hi:[0,1,1] neg_hi:[1,0,0]
    s_mov_b64 exec, s[86:87]
    v_pk_add_f32 v[54:55], v[52:53], v[60:61] op_sel:[1,1] op_sel_hi:[0,0] neg_hi:[1,0]
    v_pk_add_f32 v[52:53], v[52:53], v[60:61] neg_hi:[0,1]
    v_pk_mul_f32 v[64:65], v[54:55], s[46:47] op_sel:[0,0] op_sel_hi:[1,0]
    v_pk_fma_f32 v[94:95], v[54:55], s[46:47], v[64:65] op_sel:[1,1,0] op_sel_hi:[0,1,1] neg_hi:[1,0,0]
    v_pk_add_f32 v[54:55], v[66:67], v[58:59] op_sel:[1,1] op_sel_hi:[0,0] neg_hi:[1,0]
    v_pk_add_f32 v[66:67], v[66:67], v[58:59] neg_hi:[0,1]
    v_pk_mul_f32 v[64:65], v[54:55], s[48:49] op_sel:[0,0] op_sel_hi:[1,0]
    v_pk_fma_f32 v[92:93], v[54:55], s[48:49], v[64:65] op_sel:[1,1,0] op_sel_hi:[0,1,1] neg_hi:[1,0,0]
    v_pk_add_f32 v[54:55], v[48:49], v[68:69] op_sel:[1,1] op_sel_hi:[0,0] neg_hi:[1,0]
    v_pk_add_f32 v[48:49], v[48:49], v[68:69] neg_hi:[0,1]
    v_pk_mul_f32 v[64:65], v[54:55], s[50:51] op_sel:[0,0] op_sel_hi:[1,0]
    v_pk_fma_f32 v[90:91], v[54:55], s[50:51], v[64:65] op_sel:[1,1,0] op_sel_hi:[0,1,1] neg_hi:[1,0,0]
    s_mov_b64 exec, -1
    v_permlane32_swap_b32 v92, v94
    v_permlane32_swap_b32 v93, v95
    v_bfi_b32 v92, v31, s66, v92
    v_bfi_b32 v93, v31, s67, v93
    v_bfi_b32 v94, v31, s82, v94
    v_bfi_b32 v95, v31, s83, v95
    buffer_store_dwordx4 v[92:95], v27, s[20:23], s11 offen sc1
    v_permlane32_swap_b32 v88, v90
    v_permlane32_swap_b32 v89, v91
    v_bfi_b32 v88, v31, s66, v88
    v_bfi_b32 v89, v31, s67, v89
    v_bfi_b32 v90, v31, s82, v90
    v_bfi_b32 v91, v31, s83, v91
    buffer_store_dwordx4 v[88:91], v27, s[20:23], s10 offen sc1
    v_pk_mul_f32 v[64:65], v[66:67], s[48:49] op_sel:[0,0] op_sel_hi:[1,0]
    v_pk_fma_f32 v[84:85], v[66:67], s[48:49], v[64:65] op_sel:[1,1,0] op_sel_hi:[0,1,1] neg_hi:[1,0,0]
    v_pk_mul_f32 v[64:65], v[48:49], s[50:51] op_sel:[0,0] op_sel_hi:[1,0]
    v_pk_fma_f32 v[86:87], v[48:49], s[50:51], v[64:65] op_sel:[1,1,0] op_sel_hi:[0,1,1] neg_hi:[1,0,0]
    s_nop 1
    v_permlane32_swap_b32 v84, v86
    v_permlane32_swap_b32 v85, v87
    v_bfi_b32 v84, v31, s66, v84
    v_bfi_b32 v85, v31, s67, v85
    v_bfi_b32 v86, v31, s82, v86
    v_bfi_b32 v87, v31, s83, v87
    buffer_store_dwordx4 v[84:87], v27, s[20:23], s9 offen sc1
    v_pk_mul_f32 v[64:65], v[52:53], s[46:47] op_sel:[0,0] op_sel_hi:[1,0]
    v_pk_fma_f32 v[82:83], v[52:53], s[46:47], v[64:65] op_sel:[1,1,0] op_sel_hi:[0,1,1] neg_hi:[1,0,0]
    v_pk_mov_b32 v[80:81], v[62:63], v[62:63] op_sel:[0,1]
    s_nop 1
    v_permlane32_swap_b32 v80, v82
    v_permlane32_swap_b32 v81, v83
    v_bfi_b32 v80, v31, s66, v80
    v_bfi_b32 v81, v31, s67, v81
    v_bfi_b32 v82, v31, s82, v82
    v_bfi_b32 v83, v31, s83, v83
    buffer_store_dwordx4 v[80:83], v27, s[20:23], s8 offen sc1
    s_nop 1
    s_cmp_lt_u32 s5, 10
    s_cbranch_scc1 L_nd1
    s_waitcnt vmcnt(0)
    s_nop 1
L_nd1:
    s_and_b32 s14, s6, 1
    s_lshl_b32 s7, s3, 1
    s_add_u32 s14, s14, s7
    s_lshl_b32 s14, s14, 1
    s_add_u32 s14, s14, 130736
    v_and_b32 v104, 31, v1
    v_lshlrev_b32 v104, 5, v104
    v_lshrrev_b32 v66, 5, v1
    v_lshl_add_u32 v104, v66, 1, v104
    v_add_u32 v104, s14, v104
    v_mov_b32 v70, 0
    v_mov_b32 v71, 0
    v_mov_b32 v72, 0
    v_mov_b32 v73, 0
    v_mov_b32 v74, 0
    v_mov_b32 v75, 0
    v_mov_b32 v76, 0
    v_mov_b32 v77, 0
    v_mov_b32 v78, 0
    v_mov_b32 v79, 0
    v_mov_b32 v80, 0
    v_mov_b32 v81, 0
    v_mov_b32 v82, 0
    v_mov_b32 v83, 0
    v_mov_b32 v84, 0
    v_mov_b32 v85, 0
    ds_read_u16_d16_hi v70, v104 offset:0
    ds_read_u16_d16_hi v71, v104 offset:8192
    ds_read_u16_d16_hi v72, v104 offset:1024
    ds_read_u16_d16_hi v73, v104 offset:9216
    ds_read_u16_d16_hi v74, v104 offset:2048
    ds_read_u16_d16_hi v75, v104 offset:10240
    ds_read_u16_d16_hi v76, v104 offset:3072
    ds_read_u16_d16_hi v77, v104 offset:11264
    ds_read_u16_d16_hi v78, v104 offset:4096
    ds_read_u16_d16_hi v79, v104 offset:12288
    ds_read_u16_d16_hi v80, v104 offset:5120
    ds_read_u16_d16_hi v81, v104 offset:13312
    ds_read_u16_d16_hi v82, v104 offset:6144
    ds_read_u16_d16_hi v83, v104 offset:14336
    ds_read_u16_d16_hi v84, v104 offset:7168
    ds_read_u16_d16_hi v85, v104 offset:15360
    v_mul_u32_u24 v67, 1, v1
    v_cvt_f32_u32 v67, v67
    v_mul_f32 v67, 0x3b800000, v67
    v_fract_f32 v67, v67
    v_cos_f32 v46, v67
    v_sin_f32 v47, v67
    v_mul_u32_u24 v67, 2, v1
    v_cvt_f32_u32 v67, v67
    v_mul_f32 v67, 0x3b800000, v67
    v_fract_f32 v67, v67
    v_cos_f32 v48, v67
    v_sin_f32 v49, v67
    v_mul_u32_u24 v67, 3, v1
    v_cvt_f32_u32 v67, v67
    v_mul_f32 v67, 0x3b800000, v67
    v_fract_f32 v67, v67
    v_cos_f32 v50, v67
    v_sin_f32 v51, v67
    v_and_b32 v66, 7, v1
    v_mul_u32_u24 v67, 1, v66
    v_cvt_f32_u32 v67, v67
    v_mul_f32 v67, 0x3c800000, v67
    v_fract_f32 v67, v67
    v_cos_f32 v52, v67
    v_sin_f32 v53, v67
    v_mul_u32_u24 v67, 2, v66
    v_cvt_f32_u32 v67, v67
    v_mul_f32 v67, 0x3c800000, v67
    v_fract_f32 v67, v67
    v_cos_f32 v54, v67
    v_sin_f32 v55, v67
    v_mul_u32_u24 v67, 3, v66
    v_cvt_f32_u32 v67, v67
    v_mul_f32 v67, 0x3c800000, v67
    v_fract_f32 v67, v67
    v_cos_f32 v56, v67
    v_sin_f32 v57, v67
    v_mul_u32_u24 v67, 4, v66
    v_cvt_f32_u32 v67, v67
    v_mul_f32 v67, 0x3c800000, v67
    v_fract_f32 v67, v67
    v_cos_f32 v58, v67
    v_sin_f32 v59, v67
    v_mul_u32_u24 v67, 5, v66
    v_cvt_f32_u32 v67, v67
    v_mul_f32 v67, 0x3c800000, v67
    v_fract_f32 v67, v67
    v_cos_f32 v60, v67
    v_sin_f32 v61, v67
    v_mul_u32_u24 v67, 6, v66
    v_cvt_f32_u32 v67, v67
    v_mul_f32 v67, 0x3c800000, v67
    v_fract_f32 v67, v67
    v_cos_f32 v62, v67
    v_sin_f32 v63, v67
    v_mul_u32_u24 v67, 7, v66
    v_cvt_f32_u32 v67, v67
    v_mul_f32 v67, 0x3c800000, v67
    v_fract_f32 v67, v67
    v_cos_f32 v64, v67
    v_sin_f32 v65, v67
    v_and_b32 v68, 3, v14
    v_lshl_add_u32 v68, v66, 2, v68
    s_waitcnt lgkmcnt(0)
    v_pk_mul_f32 v[70:71], v[70:71], s[42:43]
    v_pk_mul_f32 v[72:73], v[72:73], s[42:43]
    v_pk_mul_f32 v[74:75], v[74:75], s[42:43]
    v_pk_mul_f32 v[76:77], v[76:77], s[42:43]
    v_pk_mul_f32 v[78:79], v[78:79], s[42:43]
    v_pk_mul_f32 v[80:81], v[80:81], s[42:43]
    v_pk_mul_f32 v[82:83], v[82:83], s[42:43]
    v_pk_mul_f32 v[84:85], v[84:85], s[42:43]
    s_add_u32 s20, s84, 0x100000
    s_addc_u32 s21, s85, 0
    s_mov_b32 s22, 0x508000
    s_mov_b32 s23, 0x00020000
    s_mul_i32 s8, s4, 80
    s_add_u32 s9, s8, 1318912
    s_add_u32 s10, s8, 2637824
    s_add_u32 s11, s8, 3956736
    s_mov_b32 s7, 0
    s_nop 1
Lp6:
    buffer_load_dwordx4 v[88:91], v8, s[20:23], s8 offen sc1
    buffer_load_dwordx4 v[92:95], v8, s[20:23], s9 offen sc1
    buffer_load_dwordx4 v[96:99], v8, s[20:23], s10 offen sc1
    buffer_load_dwordx4 v[100:103], v8, s[20:23], s11 offen sc1
    s_add_u32 s7, s7, 1
    s_waitcnt vmcnt(3)
    v_xor_b32 v15, s66, v88
    v_bitop3_b32 v15, v89, s67, v15 bitop3:0xbe
    v_bitop3_b32 v15, v90, s82, v15 bitop3:0xbe
    v_bitop3_b32 v15, v91, s83, v15 bitop3:0xbe
    s_waitcnt vmcnt(2)
    v_bitop3_b32 v15, v92, s66, v15 bitop3:0xbe
    v_bitop3_b32 v15, v93, s67, v15 bitop3:0xbe
    v_bitop3_b32 v15, v94, s82, v15 bitop3:0xbe
    v_bitop3_b32 v15, v95, s83, v15 bitop3:0xbe
    s_waitcnt vmcnt(1)
    v_bitop3_b32 v15, v96, s66, v15 bitop3:0xbe
    v_bitop3_b32 v15, v97, s67, v15 bitop3:0xbe
    v_bitop3_b32 v15, v98, s82, v15 bitop3:0xbe
    v_bitop3_b32 v15, v99, s83, v15 bitop3:0xbe
    s_waitcnt vmcnt(0)
    v_bitop3_b32 v15, v100, s66, v15 bitop3:0xbe
    v_bitop3_b32 v15, v101, s67, v15 bitop3:0xbe
    v_bitop3_b32 v15, v102, s82, v15 bitop3:0xbe
    v_bitop3_b32 v15, v103, s83, v15 bitop3:0xbe
    v_and_b32 v15, v31, v15
    v_cmp_ne_u32 vcc, 0, v15
    s_cmp_ge_u32 s7, 20000
    s_cbranch_scc1 Lp7
    s_and_b64 exec, exec, vcc
    s_cbranch_execnz Lp6
    s_nop 1
Lp7:
    s_mov_b64 exec, -1
    ds_write_b128 v9, v[88:91] offset:0
    ds_write_b128 v9, v[92:95] offset:1024
    ds_write_b128 v9, v[96:99] offset:2048
    ds_write_b128 v9, v[100:103] offset:3072
    s_setprio 3
    s_waitcnt lgkmcnt(0)
    s_barrier
    ds_read_b128 v[88:91], v10 offset:0
    ds_read_b128 v[96:99], v10 offset:2048
    ds_read_b128 v[92:95], v10 offset:1024
    ds_read_b128 v[100:103], v10 offset:3072
    s_waitcnt lgkmcnt(0)
    v_pk_add_f32 v[106:107], v[88:89], v[96:97]
    v_pk_add_f32 v[108:109], v[88:89], v[96:97] neg_lo:[0,1] neg_hi:[0,1]
    v_pk_add_f32 v[110:111], v[92:93], v[100:101]
    v_pk_add_f32 v[112:113], v[92:93], v[100:101] neg_lo:[0,1] neg_hi:[0,1]
    v_pk_add_f32 v[100:101], v[106:107], v[110:111]
    v_pk_add_f32 v[96:97], v[106:107], v[110:111] neg_lo:[0,1] neg_hi:[0,1]
    v_pk_add_f32 v[92:93], v[108:109], v[112:113] op_sel:[0,1] op_sel_hi:[1,0] neg_hi:[0,1]
    v_pk_add_f32 v[88:89], v[108:109], v[112:113] op_sel:[0,1] op_sel_hi:[1,0] neg_lo:[0,1]
    ds_write_b64 v11, v[100:101] offset:0
    v_pk_mul_f32 v[112:113], v[92:93], v[46:47] op_sel:[0,0] op_sel_hi:[1,0]
    v_pk_fma_f32 v[92:93], v[92:93], v[46:47], v[112:113] op_sel:[1,1,0] op_sel_hi:[0,1,1] neg_hi:[1,0,0]
    ds_write_b64 v11, v[92:93] offset:576
    v_pk_mul_f32 v[112:113], v[96:97], v[48:49] op_sel:[0,0] op_sel_hi:[1,0]
    v_pk_fma_f32 v[96:97], v[96:97], v[48:49], v[112:113] op_sel:[1,1,0] op_sel_hi:[0,1,1] neg_hi:[1,0,0]
    ds_write_b64 v11, v[96:97] offset:1152
    v_pk_mul_f32 v[112:113], v[88:89], v[50:51] op_sel:[0,0] op_sel_hi:[1,0]
    v_pk_fma_f32 v[88:89], v[88:89], v[50:51], v[112:113] op_sel:[1,1,0] op_sel_hi:[0,1,1] neg_hi:[1,0,0]
    ds_write_b64 v11, v[88:89] offset:1728
    v_pk_add_f32 v[88:89], v[90:91], v[98:99]
    v_pk_add_f32 v[96:97], v[90:91], v[98:99] neg_lo:[0,1] neg_hi:[0,1]
    v_pk_add_f32 v[92:93], v[94:95], v[102:103]
    v_pk_add_f32 v[100:101], v[94:95], v[102:103] neg_lo:[0,1] neg_hi:[0,1]
    v_pk_add_f32 v[102:103], v[88:89], v[92:93]
    v_pk_add_f32 v[98:99], v[88:89], v[92:93] neg_lo:[0,1] neg_hi:[0,1]
    v_pk_add_f32 v[94:95], v[96:97], v[100:101] op_sel:[0,1] op_sel_hi:[1,0] neg_hi:[0,1]
    v_pk_add_f32 v[90:91], v[96:97], v[100:101] op_sel:[0,1] op_sel_hi:[1,0] neg_lo:[0,1]
    ds_write_b64 v11, v[102:103] offset:2304
    v_pk_mul_f32 v[100:101], v[94:95], v[46:47] op_sel:[0,0] op_sel_hi:[1,0]
    v_pk_fma_f32 v[94:95], v[94:95], v[46:47], v[100:101] op_sel:[1,1,0] op_sel_hi:[0,1,1] neg_hi:[1,0,0]
    ds_write_b64 v11, v[94:95] offset:2880
    v_pk_mul_f32 v[100:101], v[98:99], v[48:49] op_sel:[0,0] op_sel_hi:[1,0]
    v_pk_fma_f32 v[98:99], v[98:99], v[48:49], v[100:101] op_sel:[1,1,0] op_sel_hi:[0,1,1] neg_hi:[1,0,0]
    ds_write_b64 v11, v[98:99] offset:3456
    v_pk_mul_f32 v[100:101], v[90:91], v[50:51] op_sel:[0,0] op_sel_hi:[1,0]
    v_pk_fma_f32 v[90:91], v[90:91], v[50:51], v[100:101] op_sel:[1,1,0] op_sel_hi:[0,1,1] neg_hi:[1,0,0]
    ds_write_b64 v11, v[90:91] offset:4032
    ds_read_b64 v[90:91], v12 offset:0
    ds_read_b64 v[100:101], v12 offset:256
    ds_read_b64 v[98:99], v12 offset:64
    ds_read_b64 v[92:93], v12 offset:320
    ds_read_b64 v[94:95], v12 offset:128
    ds_read_b64 v[96:97], v12 offset:384
    ds_read_b64 v[102:103], v12 offset:192
    ds_read_b64 v[88:89], v12 offset:448
    s_waitcnt lgkmcnt(6)
    v_pk_add_f32 v[112:113], v[90:91], v[100:101]
    v_pk_add_f32 v[110:111], v[90:91], v[100:101] neg_lo:[0,1] neg_hi:[0,1]
    s_waitcnt lgkmcnt(4)
    v_pk_add_f32 v[108:109], v[98:99], v[92:93]
    v_pk_add_f32 v[106:107], v[98:99], v[92:93] neg_lo:[0,1] neg_hi:[0,1]
    s_waitcnt lgkmcnt(2)
    v_pk_add_f32 v[114:115], v[94:95], v[96:97]
    v_pk_add_f32 v[116:117], v[94:95], v[96:97] neg_lo:[0,1] neg_hi:[0,1]
    s_waitcnt lgkmcnt(0)
    v_pk_add_f32 v[118:119], v[102:103], v[88:89]
    v_pk_add_f32 v[120:121], v[102:103], v[88:89] neg_lo:[0,1] neg_hi:[0,1]
    v_pk_add_f32 v[88:89], v[112:113], v[114:115]
    v_pk_add_f32 v[96:97], v[112:113], v[114:115] neg_lo:[0,1] neg_hi:[0,1]
    v_pk_add_f32 v[92:93], v[108:109], v[118:119]
    v_pk_add_f32 v[100:101], v[108:109], v[118:119] neg_lo:[0,1] neg_hi:[0,1]
    v_pk_add_f32 v[118:119], v[88:89], v[92:93]
    v_pk_add_f32 v[114:115], v[88:89], v[92:93] neg_lo:[0,1] neg_hi:[0,1]
    v_pk_add_f32 v[108:109], v[96:97], v[100:101] op_sel:[0,1] op_sel_hi:[1,0] neg_hi:[0,1]
    v_pk_add_f32 v[112:113], v[96:97], v[100:101] op_sel:[0,1] op_sel_hi:[1,0] neg_lo:[0,1]
    v_pk_add_f32 v[100:101], v[106:107], v[106:107] op_sel:[0,1] op_sel_hi:[1,0] neg_hi:[0,1]
    v_pk_add_f32 v[92:93], v[120:121], v[120:121] op_sel:[0,1] op_sel_hi:[1,0] neg_lo:[1,0] neg_hi:[1,1]
    v_pk_add_f32 v[96:97], v[110:111], v[116:117] op_sel:[0,1] op_sel_hi:[1,0] neg_hi:[0,1]
    v_pk_add_f32 v[88:89], v[110:111], v[116:117] op_sel:[0,1] op_sel_hi:[1,0] neg_lo:[0,1]
    v_pk_add_f32 v[120:121], v[100:101], v[92:93]
    v_pk_add_f32 v[116:117], v[100:101], v[92:93] neg_lo:[0,1] neg_hi:[0,1]
    v_pk_fma_f32 v[92:93], v[120:121], s[32:33], v[96:97]
    v_pk_fma_f32 v[100:101], v[120:121], s[32:33], v[96:97] neg_lo:[1,0,0] neg_hi:[1,0,0]
    v_pk_fma_f32 v[106:107], v[116:117], s[32:33], v[88:89] op_sel:[1,0,0] op_sel_hi:[0,1,1] neg_hi:[1,0,0]
    v_pk_fma_f32 v[110:111], v[116:117], s[32:33], v[88:89] op_sel:[1,0,0] op_sel_hi:[0,1,1] neg_lo:[1,0,0]
    s_setprio 2
    ds_write_b64 v12, v[118:119] offset:0
    v_pk_mul_f32 v[116:117], v[92:93], v[52:53] op_sel:[0,0] op_sel_hi:[1,0]
    v_pk_fma_f32 v[92:93], v[92:93], v[52:53], v[116:117] op_sel:[1,1,0] op_sel_hi:[0,1,1] neg_hi:[1,0,0]
    ds_write_b64 v12, v[92:93] offset:72
    v_pk_mul_f32 v[116:117], v[108:109], v[54:55] op_sel:[0,0] op_sel_hi:[1,0]
    v_pk_fma_f32 v[108:109], v[108:109], v[54:55], v[116:117] op_sel:[1,1,0] op_sel_hi:[0,1,1] neg_hi:[1,0,0]
    ds_write_b64 v12, v[108:109] offset:144
    v_pk_mul_f32 v[116:117], v[106:107], v[56:57] op_sel:[0,0] op_sel_hi:[1,0]
    v_pk_fma_f32 v[106:107], v[106:107], v[56:57], v[116:117] op_sel:[1,1,0] op_sel_hi:[0,1,1] neg_hi:[1,0,0]
    ds_write_b64 v12, v[106:107] offset:216
    v_pk_mul_f32 v[116:117], v[114:115], v[58:59] op_sel:[0,0] op_sel_hi:[1,0]
    v_pk_fma_f32 v[114:115], v[114:115], v[58:59], v[116:117] op_sel:[1,1,0] op_sel_hi:[0,1,1] neg_hi:[1,0,0]
    ds_write_b64 v12, v[114:115] offset:288
    v_pk_mul_f32 v[116:117], v[100:101], v[60:61] op_sel:[0,0] op_sel_hi:[1,0]
    v_pk_fma_f32 v[100:101], v[100:101], v[60:61], v[116:117] op_sel:[1,1,0] op_sel_hi:[0,1,1] neg_hi:[1,0,0]
    ds_write_b64 v12, v[100:101] offset:360
    v_pk_mul_f32 v[116:117], v[112:113], v[62:63] op_sel:[0,0] op_sel_hi:[1,0]
    v_pk_fma_f32 v[112:113], v[112:113], v[62:63], v[116:117] op_sel:[1,1,0] op_sel_hi:[0,1,1] neg_hi:[1,0,0]
    ds_write_b64 v12, v[112:113] offset:432
    v_pk_mul_f32 v[116:117], v[110:111], v[64:65] op_sel:[0,0] op_sel_hi:[1,0]
    v_pk_fma_f32 v[110:111], v[110:111], v[64:65], v[116:117] op_sel:[1,1,0] op_sel_hi:[0,1,1] neg_hi:[1,0,0]
    ds_write_b64 v12, v[110:111] offset:504
    ds_read_b64 v[110:111], v13 offset:0
    ds_read_b64 v[106:107], v13 offset:32
    ds_read_b64 v[112:113], v13 offset:8
    ds_read_b64 v[108:109], v13 offset:40
    ds_read_b64 v[100:101], v13 offset:16
    ds_read_b64 v[92:93], v13 offset:48
    ds_read_b64 v[114:115], v13 offset:24
    ds_read_b64 v[118:119], v13 offset:56
    s_waitcnt lgkmcnt(6)
    v_pk_add_f32 v[116:117], v[110:111], v[106:107]
    v_pk_add_f32 v[120:121], v[110:111], v[106:107] neg_lo:[0,1] neg_hi:[0,1]
    s_waitcnt lgkmcnt(4)
    v_pk_add_f32 v[88:89], v[112:113], v[108:109]
    v_pk_add_f32 v[96:97], v[112:113], v[108:109] neg_lo:[0,1] neg_hi:[0,1]
    s_waitcnt lgkmcnt(2)
    v_pk_add_f32 v[102:103], v[100:101], v[92:93]
    v_pk_add_f32 v[94:95], v[100:101], v[92:93] neg_lo:[0,1] neg_hi:[0,1]
    s_waitcnt lgkmcnt(0)
    v_pk_add_f32 v[98:99], v[114:115], v[118:119]
    v_pk_add_f32 v[90:91], v[114:115], v[118:119] neg_lo:[0,1] neg_hi:[0,1]
    v_pk_add_f32 v[118:119], v[116:117], v[102:103]
    v_pk_add_f32 v[92:93], v[116:117], v[102:103] neg_lo:[0,1] neg_hi:[0,1]
    v_pk_add_f32 v[108:109], v[88:89], v[98:99]
    v_pk_add_f32 v[106:107], v[88:89], v[98:99] neg_lo:[0,1] neg_hi:[0,1]
    v_pk_add_f32 v[98:99], v[118:119], v[108:109]
    v_pk_add_f32 v[102:103], v[118:119], v[108:109] neg_lo:[0,1] neg_hi:[0,1]
    v_pk_add_f32 v[88:89], v[92:93], v[106:107] op_sel:[0,1] op_sel_hi:[1,0] neg_hi:[0,1]
    v_pk_add_f32 v[116:117], v[92:93], v[106:107] op_sel:[0,1] op_sel_hi:[1,0] neg_lo:[0,1]
    v_pk_add_f32 v[106:107], v[96:97], v[96:97] op_sel:[0,1] op_sel_hi:[1,0] neg_hi:[0,1]
    v_pk_add_f32 v[108:109], v[90:91], v[90:91] op_sel:[0,1] op_sel_hi:[1,0] neg_lo:[1,0] neg_hi:[1,1]
    v_pk_add_f32 v[92:93], v[120:121], v[94:95] op_sel:[0,1] op_sel_hi:[1,0] neg_hi:[0,1]
    v_pk_add_f32 v[118:119], v[120:121], v[94:95] op_sel:[0,1] op_sel_hi:[1,0] neg_lo:[0,1]
    v_pk_add_f32 v[90:91], v[106:107], v[108:109]
    v_pk_add_f32 v[94:95], v[106:107], v[108:109] neg_lo:[0,1] neg_hi:[0,1]
    v_pk_fma_f32 v[108:109], v[90:91], s[32:33], v[92:93]
    v_pk_fma_f32 v[106:107], v[90:91], s[32:33], v[92:93] neg_lo:[1,0,0] neg_hi:[1,0,0]
    v_pk_fma_f32 v[96:97], v[94:95], s[32:33], v[118:119] op_sel:[1,0,0] op_sel_hi:[0,1,1] neg_hi:[1,0,0]
    v_pk_fma_f32 v[120:121], v[94:95], s[32:33], v[118:119] op_sel:[1,0,0] op_sel_hi:[0,1,1] neg_lo:[1,0,0]
    s_or_b32 s14, s5, s3
    s_cmp_eq_u32 s14, 0
    s_cbranch_scc1 L_p2sp
    v_pk_mul_f32 v[94:95], v[98:99], v[70:71] op_sel:[0,0] op_sel_hi:[1,0]
    v_pk_fma_f32 v[98:99], v[98:99], v[70:71], v[94:95] op_sel:[1,1,0] op_sel_hi:[0,1,1] neg_lo:[1,0,0]
    v_pk_mul_f32 v[94:95], v[108:109], v[72:73] op_sel:[0,0] op_sel_hi:[1,0]
    v_pk_fma_f32 v[108:109], v[108:109], v[72:73], v[94:95] op_sel:[1,1,0] op_sel_hi:[0,1,1] neg_lo:[1,0,0]
    v_pk_mul_f32 v[94:95], v[88:89], v[74:75] op_sel:[0,0] op_sel_hi:[1,0]
    v_pk_fma_f32 v[88:89], v[88:89], v[74:75], v[94:95] op_sel:[1,1,0] op_sel_hi:[0,1,1] neg_lo:[1,0,0]
    v_pk_mul_f32 v[94:95], v[96:97], v[76:77] op_sel:[0,0] op_sel_hi:[1,0]
    v_pk_fma_f32 v[96:97], v[96:97], v[76:77], v[94:95] op_sel:[1,1,0] op_sel_hi:[0,1,1] neg_lo:[1,0,0]
    v_pk_mul_f32 v[94:95], v[102:103], v[78:79] op_sel:[0,0] op_sel_hi:[1,0]
    v_pk_fma_f32 v[102:103], v[102:103], v[78:79], v[94:95] op_sel:[1,1,0] op_sel_hi:[0,1,1] neg_lo:[1,0,0]
    v_pk_mul_f32 v[94:95], v[106:107], v[80:81] op_sel:[0,0] op_sel_hi:[1,0]
    v_pk_fma_f32 v[106:107], v[106:107], v[80:81], v[94:95] op_sel:[1,1,0] op_sel_hi:[0,1,1] neg_lo:[1,0,0]
    v_pk_mul_f32 v[94:95], v[116:117], v[82:83] op_sel:[0,0] op_sel_hi:[1,0]
    v_pk_fma_f32 v[116:117], v[116:117], v[82:83], v[94:95] op_sel:[1,1,0] op_sel_hi:[0,1,1] neg_lo:[1,0,0]
    v_pk_mul_f32 v[94:95], v[120:121], v[84:85] op_sel:[0,0] op_sel_hi:[1,0]
    v_pk_fma_f32 v[120:121], v[120:121], v[84:85], v[94:95] op_sel:[1,1,0] op_sel_hi:[0,1,1] neg_lo:[1,0,0]
    s_branch L_p2inv
    s_nop 1
L_p2sp:
    s_mov_b32 exec_lo, 0
    v_pk_mul_f32 v[90:91], v[98:99], v[70:71] op_sel:[0,0] op_sel_hi:[1,0]
    v_pk_fma_f32 v[98:99], v[98:99], v[70:71], v[90:91] op_sel:[1,1,0] op_sel_hi:[0,1,1] neg_lo:[1,0,0]
    v_pk_mul_f32 v[90:91], v[108:109], v[72:73] op_sel:[0,0] op_sel_hi:[1,0]
    v_pk_fma_f32 v[108:109], v[108:109], v[72:73], v[90:91] op_sel:[1,1,0] op_sel_hi:[0,1,1] neg_lo:[1,0,0]
    v_pk_mul_f32 v[90:91], v[88:89], v[74:75] op_sel:[0,0] op_sel_hi:[1,0]
    v_pk_fma_f32 v[88:89], v[88:89], v[74:75], v[90:91] op_sel:[1,1,0] op_sel_hi:[0,1,1] neg_lo:[1,0,0]
    v_pk_mul_f32 v[90:91], v[96:97], v[76:77] op_sel:[0,0] op_sel_hi:[1,0]
    v_pk_fma_f32 v[96:97], v[96:97], v[76:77], v[90:91] op_sel:[1,1,0] op_sel_hi:[0,1,1] neg_lo:[1,0,0]
    v_pk_mul_f32 v[90:91], v[102:103], v[78:79] op_sel:[0,0] op_sel_hi:[1,0]
    v_pk_fma_f32 v[102:103], v[102:103], v[78:79], v[90:91] op_sel:[1,1,0] op_sel_hi:[0,1,1] neg_lo:[1,0,0]
    v_pk_mul_f32 v[90:91], v[106:107], v[80:81] op_sel:[0,0] op_sel_hi:[1,0]
    v_pk_fma_f32 v[106:107], v[106:107], v[80:81], v[90:91] op_sel:[1,1,0] op_sel_hi:[0,1,1] neg_lo:[1,0,0]
    v_pk_mul_f32 v[90:91], v[116:117], v[82:83] op_sel:[0,0] op_sel_hi:[1,0]
    v_pk_fma_f32 v[116:117], v[116:117], v[82:83], v[90:91] op_sel:[1,1,0] op_sel_hi:[0,1,1] neg_lo:[1,0,0]
    v_pk_mul_f32 v[90:91], v[120:121], v[84:85] op_sel:[0,0] op_sel_hi:[1,0]
    v_pk_fma_f32 v[120:121], v[120:121], v[84:85], v[90:91] op_sel:[1,1,0] op_sel_hi:[0,1,1] neg_lo:[1,0,0]
    s_mov_b32 exec_lo, -1
    s_mov_b32 exec_hi, 0
    v_lshlrev_b32 v122, 3, v68
    ds_write_b64 v122, v[98:99] offset:24320
    ds_write_b64 v122, v[108:109] offset:24576
    ds_write_b64 v122, v[88:89] offset:24832
    ds_write_b64 v122, v[96:97] offset:25088
    ds_write_b64 v122, v[102:103] offset:25344
    ds_write_b64 v122, v[106:107] offset:25600
    ds_write_b64 v122, v[116:117] offset:25856
    ds_write_b64 v122, v[120:121] offset:26112
    s_cmp_eq_u32 s6, 0
    s_movk_i32 s14, 255
    s_cselect_b32 s14, 256, s14
    v_lshlrev_b32 v122, 4, v1
    v_add_u32 v122, 65200, v122
    s_waitcnt lgkmcnt(0)
    v_sub_u32 v123, s14, v68
    v_subrev_u32 v123, 0, v123
    v_and_b32 v123, 255, v123
    v_lshlrev_b32 v123, 3, v123
    ds_read_b64 v[70:71], v123 offset:24320
    v_sub_u32 v123, s14, v68
    v_subrev_u32 v123, 32, v123
    v_and_b32 v123, 255, v123
    v_lshlrev_b32 v123, 3, v123
    ds_read_b64 v[72:73], v123 offset:24320
    v_sub_u32 v123, s14, v68
    v_subrev_u32 v123, 64, v123
    v_and_b32 v123, 255, v123
    v_lshlrev_b32 v123, 3, v123
    ds_read_b64 v[74:75], v123 offset:24320
    v_sub_u32 v123, s14, v68
    v_subrev_u32 v123, 96, v123
    v_and_b32 v123, 255, v123
    v_lshlrev_b32 v123, 3, v123
    ds_read_b64 v[76:77], v123 offset:24320
    v_sub_u32 v123, s14, v68
    v_subrev_u32 v123, 128, v123
    v_and_b32 v123, 255, v123
    v_lshlrev_b32 v123, 3, v123
    ds_read_b64 v[78:79], v123 offset:24320
    v_sub_u32 v123, s14, v68
    v_subrev_u32 v123, 160, v123
    v_and_b32 v123, 255, v123
    v_lshlrev_b32 v123, 3, v123
    ds_read_b64 v[80:81], v123 offset:24320
    v_sub_u32 v123, s14, v68
    v_subrev_u32 v123, 192, v123
    v_and_b32 v123, 255, v123
    v_lshlrev_b32 v123, 3, v123
    ds_read_b64 v[82:83], v123 offset:24320
    v_sub_u32 v123, s14, v68
    v_subrev_u32 v123, 224, v123
    v_and_b32 v123, 255, v123
    v_lshlrev_b32 v123, 3, v123
    ds_read_b64 v[84:85], v123 offset:24320
    ds_read_b128 v[124:127], v122 offset:0
    s_waitcnt lgkmcnt(0)
    v_pk_mul_f32 v[90:91], v[98:99], v[124:125] op_sel:[0,0] op_sel_hi:[1,0]
    v_pk_fma_f32 v[98:99], v[98:99], v[124:125], v[90:91] op_sel:[1,1,0] op_sel_hi:[0,1,1] neg_lo:[1,0,0]
    v_pk_fma_f32 v[98:99], v[70:71], v[126:127], v[98:99] op_sel:[0,0,0] op_sel_hi:[0,1,1]
    v_pk_fma_f32 v[98:99], v[70:71], v[126:127], v[98:99] op_sel:[1,1,0] op_sel_hi:[1,0,1] neg_hi:[0,1,0]
    ds_read_b128 v[124:127], v122 offset:512
    s_waitcnt lgkmcnt(0)
    v_pk_mul_f32 v[90:91], v[108:109], v[124:125] op_sel:[0,0] op_sel_hi:[1,0]
    v_pk_fma_f32 v[108:109], v[108:109], v[124:125], v[90:91] op_sel:[1,1,0] op_sel_hi:[0,1,1] neg_lo:[1,0,0]
    v_pk_fma_f32 v[108:109], v[72:73], v[126:127], v[108:109] op_sel:[0,0,0] op_sel_hi:[0,1,1]
    v_pk_fma_f32 v[108:109], v[72:73], v[126:127], v[108:109] op_sel:[1,1,0] op_sel_hi:[1,0,1] neg_hi:[0,1,0]
    ds_read_b128 v[124:127], v122 offset:1024
    s_waitcnt lgkmcnt(0)
    v_pk_mul_f32 v[90:91], v[88:89], v[124:125] op_sel:[0,0] op_sel_hi:[1,0]
    v_pk_fma_f32 v[88:89], v[88:89], v[124:125], v[90:91] op_sel:[1,1,0] op_sel_hi:[0,1,1] neg_lo:[1,0,0]
    v_pk_fma_f32 v[88:89], v[74:75], v[126:127], v[88:89] op_sel:[0,0,0] op_sel_hi:[0,1,1]
    v_pk_fma_f32 v[88:89], v[74:75], v[126:127], v[88:89] op_sel:[1,1,0] op_sel_hi:[1,0,1] neg_hi:[0,1,0]
    ds_read_b128 v[124:127], v122 offset:1536
    s_waitcnt lgkmcnt(0)
    v_pk_mul_f32 v[90:91], v[96:97], v[124:125] op_sel:[0,0] op_sel_hi:[1,0]
    v_pk_fma_f32 v[96:97], v[96:97], v[124:125], v[90:91] op_sel:[1,1,0] op_sel_hi:[0,1,1] neg_lo:[1,0,0]
    v_pk_fma_f32 v[96:97], v[76:77], v[126:127], v[96:97] op_sel:[0,0,0] op_sel_hi:[0,1,1]
    v_pk_fma_f32 v[96:97], v[76:77], v[126:127], v[96:97] op_sel:[1,1,0] op_sel_hi:[1,0,1] neg_hi:[0,1,0]
    ds_read_b128 v[124:127], v122 offset:2048
    s_waitcnt lgkmcnt(0)
    v_pk_mul_f32 v[90:91], v[102:103], v[124:125] op_sel:[0,0] op_sel_hi:[1,0]
    v_pk_fma_f32 v[102:103], v[102:103], v[124:125], v[90:91] op_sel:[1,1,0] op_sel_hi:[0,1,1] neg_lo:[1,0,0]
    v_pk_fma_f32 v[102:103], v[78:79], v[126:127], v[102:103] op_sel:[0,0,0] op_sel_hi:[0,1,1]
    v_pk_fma_f32 v[102:103], v[78:79], v[126:127], v[102:103] op_sel:[1,1,0] op_sel_hi:[1,0,1] neg_hi:[0,1,0]
    ds_read_b128 v[124:127], v122 offset:2560
    s_waitcnt lgkmcnt(0)
    v_pk_mul_f32 v[90:91], v[106:107], v[124:125] op_sel:[0,0] op_sel_hi:[1,0]
    v_pk_fma_f32 v[106:107], v[106:107], v[124:125], v[90:91] op_sel:[1,1,0] op_sel_hi:[0,1,1] neg_lo:[1,0,0]
    v_pk_fma_f32 v[106:107], v[80:81], v[126:127], v[106:107] op_sel:[0,0,0] op_sel_hi:[0,1,1]
    v_pk_fma_f32 v[106:107], v[80:81], v[126:127], v[106:107] op_sel:[1,1,0] op_sel_hi:[1,0,1] neg_hi:[0,1,0]
    ds_read_b128 v[124:127], v122 offset:3072
    s_waitcnt lgkmcnt(0)
    v_pk_mul_f32 v[90:91], v[116:117], v[124:125] op_sel:[0,0] op_sel_hi:[1,0]
    v_pk_fma_f32 v[116:117], v[116:117], v[124:125], v[90:91] op_sel:[1,1,0] op_sel_hi:[0,1,1] neg_lo:[1,0,0]
    v_pk_fma_f32 v[116:117], v[82:83], v[126:127], v[116:117] op_sel:[0,0,0] op_sel_hi:[0,1,1]
    v_pk_fma_f32 v[116:117], v[82:83], v[126:127], v[116:117] op_sel:[1,1,0] op_sel_hi:[1,0,1] neg_hi:[0,1,0]
    ds_read_b128 v[124:127], v122 offset:3584
    s_waitcnt lgkmcnt(0)
    v_pk_mul_f32 v[90:91], v[120:121], v[124:125] op_sel:[0,0] op_sel_hi:[1,0]
    v_pk_fma_f32 v[120:121], v[120:121], v[124:125], v[90:91] op_sel:[1,1,0] op_sel_hi:[0,1,1] neg_lo:[1,0,0]
    v_pk_fma_f32 v[120:121], v[84:85], v[126:127], v[120:121] op_sel:[0,0,0] op_sel_hi:[0,1,1]
    v_pk_fma_f32 v[120:121], v[84:85], v[126:127], v[120:121] op_sel:[1,1,0] op_sel_hi:[1,0,1] neg_hi:[0,1,0]
    s_mov_b64 exec, -1
    s_branch L_p2inv
    .p2align 6
    s_nop 1
L_p2inv:
    s_setprio 1
    v_pk_add_f32 v[84:85], v[98:99], v[102:103]
    v_pk_add_f32 v[82:83], v[98:99], v[102:103] neg_lo:[0,1] neg_hi:[0,1]
    v_pk_add_f32 v[80:81], v[108:109], v[106:107]
    v_pk_add_f32 v[78:79], v[108:109], v[106:107] neg_lo:[0,1] neg_hi:[0,1]
    v_pk_add_f32 v[76:77], v[88:89], v[116:117]
    v_pk_add_f32 v[74:75], v[88:89], v[116:117] neg_lo:[0,1] neg_hi:[0,1]
    v_pk_add_f32 v[72:73], v[96:97], v[120:121]
    v_pk_add_f32 v[70:71], v[96:97], v[120:121] neg_lo:[0,1] neg_hi:[0,1]
    v_pk_add_f32 v[120:121], v[84:85], v[76:77]
    v_pk_add_f32 v[116:117], v[84:85], v[76:77] neg_lo:[0,1] neg_hi:[0,1]
    v_pk_add_f32 v[106:107], v[80:81], v[72:73]
    v_pk_add_f32 v[102:103], v[80:81], v[72:73] neg_lo:[0,1] neg_hi:[0,1]
    v_pk_add_f32 v[72:73], v[120:121], v[106:107]
    v_pk_add_f32 v[76:77], v[120:121], v[106:107] neg_lo:[0,1] neg_hi:[0,1]
    v_pk_add_f32 v[80:81], v[116:117], v[102:103] op_sel:[0,1] op_sel_hi:[1,0] neg_lo:[0,1]
    v_pk_add_f32 v[84:85], v[116:117], v[102:103] op_sel:[0,1] op_sel_hi:[1,0] neg_hi:[0,1]
    v_pk_add_f32 v[102:103], v[78:79], v[78:79] op_sel:[0,1] op_sel_hi:[1,0] neg_lo:[0,1]
    v_pk_add_f32 v[106:107], v[70:71], v[70:71] op_sel:[0,1] op_sel_hi:[1,0] neg_lo:[1,1] neg_hi:[1,0]
    v_pk_add_f32 v[116:117], v[82:83], v[74:75] op_sel:[0,1] op_sel_hi:[1,0] neg_lo:[0,1]
    v_pk_add_f32 v[120:121], v[82:83], v[74:75] op_sel:[0,1] op_sel_hi:[1,0] neg_hi:[0,1]
    v_pk_add_f32 v[70:71], v[102:103], v[106:107]
    v_pk_add_f32 v[74:75], v[102:103], v[106:107] neg_lo:[0,1] neg_hi:[0,1]
    v_pk_fma_f32 v[106:107], v[70:71], s[32:33], v[116:117]
    v_pk_fma_f32 v[102:103], v[70:71], s[32:33], v[116:117] neg_lo:[1,0,0] neg_hi:[1,0,0]
    v_pk_fma_f32 v[78:79], v[74:75], s[32:33], v[120:121] op_sel:[1,0,0] op_sel_hi:[0,1,1] neg_lo:[1,0,0]
    v_pk_fma_f32 v[82:83], v[74:75], s[32:33], v[120:121] op_sel:[1,0,0] op_sel_hi:[0,1,1] neg_hi:[1,0,0]
    ds_write_b64 v13, v[72:73] offset:0
    ds_write_b64 v13, v[106:107] offset:8
    ds_write_b64 v13, v[80:81] offset:16
    ds_write_b64 v13, v[78:79] offset:24
    ds_write_b64 v13, v[76:77] offset:32
    ds_write_b64 v13, v[102:103] offset:40
    ds_write_b64 v13, v[84:85] offset:48
    ds_write_b64 v13, v[82:83] offset:56
    ds_read_b64 v[82:83], v12 offset:0
    ds_read_b64 v[78:79], v12 offset:288
    ds_read_b64 v[84:85], v12 offset:72
    ds_read_b64 v[80:81], v12 offset:360
    ds_read_b64 v[102:103], v12 offset:144
    ds_read_b64 v[106:107], v12 offset:432
    ds_read_b64 v[76:77], v12 offset:216
    ds_read_b64 v[72:73], v12 offset:504
    s_waitcnt lgkmcnt(6)
    v_pk_mul_f32 v[74:75], v[78:79], v[58:59] op_sel:[0,0] op_sel_hi:[1,0]
    v_pk_fma_f32 v[78:79], v[78:79], v[58:59], v[74:75] op_sel:[1,1,0] op_sel_hi:[0,1,1] neg_lo:[1,0,0]
    v_pk_add_f32 v[74:75], v[82:83], v[78:79]
    v_pk_add_f32 v[70:71], v[82:83], v[78:79] neg_lo:[0,1] neg_hi:[0,1]
    s_waitcnt lgkmcnt(4)
    v_pk_mul_f32 v[120:121], v[84:85], v[52:53] op_sel:[0,0] op_sel_hi:[1,0]
    v_pk_fma_f32 v[84:85], v[84:85], v[52:53], v[120:121] op_sel:[1,1,0] op_sel_hi:[0,1,1] neg_lo:[1,0,0]
    v_pk_mul_f32 v[120:121], v[80:81], v[60:61] op_sel:[0,0] op_sel_hi:[1,0]
    v_pk_fma_f32 v[80:81], v[80:81], v[60:61], v[120:121] op_sel:[1,1,0] op_sel_hi:[0,1,1] neg_lo:[1,0,0]
    v_pk_add_f32 v[120:121], v[84:85], v[80:81]
    v_pk_add_f32 v[116:117], v[84:85], v[80:81] neg_lo:[0,1] neg_hi:[0,1]
    s_waitcnt lgkmcnt(2)
    v_pk_mul_f32 v[96:97], v[102:103], v[54:55] op_sel:[0,0] op_sel_hi:[1,0]
    v_pk_fma_f32 v[102:103], v[102:103], v[54:55], v[96:97] op_sel:[1,1,0] op_sel_hi:[0,1,1] neg_lo:[1,0,0]
    v_pk_mul_f32 v[96:97], v[106:107], v[62:63] op_sel:[0,0] op_sel_hi:[1,0]
    v_pk_fma_f32 v[106:107], v[106:107], v[62:63], v[96:97] op_sel:[1,1,0] op_sel_hi:[0,1,1] neg_lo:[1,0,0]
    v_pk_add_f32 v[96:97], v[102:103], v[106:107]
    v_pk_add_f32 v[88:89], v[102:103], v[106:107] neg_lo:[0,1] neg_hi:[0,1]
    s_waitcnt lgkmcnt(0)
    v_pk_mul_f32 v[108:109], v[76:77], v[56:57] op_sel:[0,0] op_sel_hi:[1,0]
    v_pk_fma_f32 v[76:77], v[76:77], v[56:57], v[108:109] op_sel:[1,1,0] op_sel_hi:[0,1,1] neg_lo:[1,0,0]
    v_pk_mul_f32 v[108:109], v[72:73], v[64:65] op_sel:[0,0] op_sel_hi:[1,0]
    v_pk_fma_f32 v[72:73], v[72:73], v[64:65], v[108:109] op_sel:[1,1,0] op_sel_hi:[0,1,1] neg_lo:[1,0,0]
    v_pk_add_f32 v[108:109], v[76:77], v[72:73]
    v_pk_add_f32 v[98:99], v[76:77], v[72:73] neg_lo:[0,1] neg_hi:[0,1]
    v_pk_add_f32 v[72:73], v[74:75], v[96:97]
    v_pk_add_f32 v[106:107], v[74:75], v[96:97] neg_lo:[0,1] neg_hi:[0,1]
    v_pk_add_f32 v[80:81], v[120:121], v[108:109]
    v_pk_add_f32 v[78:79], v[120:121], v[108:109] neg_lo:[0,1] neg_hi:[0,1]
    v_pk_add_f32 v[108:109], v[72:73], v[80:81]
    v_pk_add_f32 v[96:97], v[72:73], v[80:81] neg_lo:[0,1] neg_hi:[0,1]
    v_pk_add_f32 v[120:121], v[106:107], v[78:79] op_sel:[0,1] op_sel_hi:[1,0] neg_lo:[0,1]
    v_pk_add_f32 v[74:75], v[106:107], v[78:79] op_sel:[0,1] op_sel_hi:[1,0] neg_hi:[0,1]
    v_pk_add_f32 v[78:79], v[116:117], v[116:117] op_sel:[0,1] op_sel_hi:[1,0] neg_lo:[0,1]
    v_pk_add_f32 v[80:81], v[98:99], v[98:99] op_sel:[0,1] op_sel_hi:[1,0] neg_lo:[1,1] neg_hi:[1,0]
    v_pk_add_f32 v[106:107], v[70:71], v[88:89] op_sel:[0,1] op_sel_hi:[1,0] neg_lo:[0,1]
    v_pk_add_f32 v[72:73], v[70:71], v[88:89] op_sel:[0,1] op_sel_hi:[1,0] neg_hi:[0,1]
    v_pk_add_f32 v[98:99], v[78:79], v[80:81]
    v_pk_add_f32 v[88:89], v[78:79], v[80:81] neg_lo:[0,1] neg_hi:[0,1]
    v_pk_fma_f32 v[80:81], v[98:99], s[32:33], v[106:107]
    v_pk_fma_f32 v[78:79], v[98:99], s[32:33], v[106:107] neg_lo:[1,0,0] neg_hi:[1,0,0]
    v_pk_fma_f32 v[116:117], v[88:89], s[32:33], v[72:73] op_sel:[1,0,0] op_sel_hi:[0,1,1] neg_lo:[1,0,0]
    v_pk_fma_f32 v[70:71], v[88:89], s[32:33], v[72:73] op_sel:[1,0,0] op_sel_hi:[0,1,1] neg_hi:[1,0,0]
    s_setprio 0
    ds_write_b64 v12, v[108:109] offset:0
    ds_write_b64 v12, v[80:81] offset:64
    ds_write_b64 v12, v[120:121] offset:128
    ds_write_b64 v12, v[116:117] offset:192
    ds_write_b64 v12, v[96:97] offset:256
    ds_write_b64 v12, v[78:79] offset:320
    ds_write_b64 v12, v[74:75] offset:384
    ds_write_b64 v12, v[70:71] offset:448
    ds_read_b64 v[70:71], v11 offset:0
    ds_read_b64 v[74:75], v11 offset:576
    ds_read_b64 v[78:79], v11 offset:1152
    ds_read_b64 v[96:97], v11 offset:1728
    ds_read_b64 v[116:117], v11 offset:2304
    ds_read_b64 v[120:121], v11 offset:2880
    ds_read_b64 v[80:81], v11 offset:3456
    ds_read_b64 v[108:109], v11 offset:4032
    s_waitcnt lgkmcnt(6)
    v_pk_mul_f32 v[88:89], v[74:75], v[46:47] op_sel:[0,0] op_sel_hi:[1,0]
    v_pk_fma_f32 v[74:75], v[74:75], v[46:47], v[88:89] op_sel:[1,1,0] op_sel_hi:[0,1,1] neg_lo:[1,0,0]
    s_waitcnt lgkmcnt(5)
    v_pk_mul_f32 v[88:89], v[78:79], v[48:49] op_sel:[0,0] op_sel_hi:[1,0]
    v_pk_fma_f32 v[78:79], v[78:79], v[48:49], v[88:89] op_sel:[1,1,0] op_sel_hi:[0,1,1] neg_lo:[1,0,0]
    s_waitcnt lgkmcnt(4)
    v_pk_mul_f32 v[88:89], v[96:97], v[50:51] op_sel:[0,0] op_sel_hi:[1,0]
    v_pk_fma_f32 v[96:97], v[96:97], v[50:51], v[88:89] op_sel:[1,1,0] op_sel_hi:[0,1,1] neg_lo:[1,0,0]
    v_pk_add_f32 v[88:89], v[70:71], v[78:79]
    v_pk_add_f32 v[98:99], v[70:71], v[78:79] neg_lo:[0,1] neg_hi:[0,1]
    v_pk_add_f32 v[72:73], v[74:75], v[96:97]
    v_pk_add_f32 v[106:107], v[74:75], v[96:97] neg_lo:[0,1] neg_hi:[0,1]
    v_pk_add_f32 v[96:97], v[88:89], v[72:73]
    v_pk_add_f32 v[78:79], v[88:89], v[72:73] neg_lo:[0,1] neg_hi:[0,1]
    v_pk_add_f32 v[74:75], v[98:99], v[106:107] op_sel:[0,1] op_sel_hi:[1,0] neg_lo:[0,1]
    v_pk_add_f32 v[70:71], v[98:99], v[106:107] op_sel:[0,1] op_sel_hi:[1,0] neg_hi:[0,1]
    ds_write_b64 v10, v[96:97] offset:0
    ds_write_b64 v10, v[74:75] offset:1024
    ds_write_b64 v10, v[78:79] offset:2048
    ds_write_b64 v10, v[70:71] offset:3072
    s_waitcnt lgkmcnt(6)
    v_pk_mul_f32 v[70:71], v[120:121], v[46:47] op_sel:[0,0] op_sel_hi:[1,0]
    v_pk_fma_f32 v[120:121], v[120:121], v[46:47], v[70:71] op_sel:[1,1,0] op_sel_hi:[0,1,1] neg_lo:[1,0,0]
    s_waitcnt lgkmcnt(5)
    v_pk_mul_f32 v[70:71], v[80:81], v[48:49] op_sel:[0,0] op_sel_hi:[1,0]
    v_pk_fma_f32 v[80:81], v[80:81], v[48:49], v[70:71] op_sel:[1,1,0] op_sel_hi:[0,1,1] neg_lo:[1,0,0]
    s_waitcnt lgkmcnt(4)
    v_pk_mul_f32 v[70:71], v[108:109], v[50:51] op_sel:[0,0] op_sel_hi:[1,0]
    v_pk_fma_f32 v[108:109], v[108:109], v[50:51], v[70:71] op_sel:[1,1,0] op_sel_hi:[0,1,1] neg_lo:[1,0,0]
    v_pk_add_f32 v[70:71], v[116:117], v[80:81]
    v_pk_add_f32 v[78:79], v[116:117], v[80:81] neg_lo:[0,1] neg_hi:[0,1]
    v_pk_add_f32 v[74:75], v[120:121], v[108:109]
    v_pk_add_f32 v[96:97], v[120:121], v[108:109] neg_lo:[0,1] neg_hi:[0,1]
    v_pk_add_f32 v[108:109], v[70:71], v[74:75]
    v_pk_add_f32 v[80:81], v[70:71], v[74:75] neg_lo:[0,1] neg_hi:[0,1]
    v_pk_add_f32 v[120:121], v[78:79], v[96:97] op_sel:[0,1] op_sel_hi:[1,0] neg_lo:[0,1]
    v_pk_add_f32 v[116:117], v[78:79], v[96:97] op_sel:[0,1] op_sel_hi:[1,0] neg_hi:[0,1]
    ds_write_b64 v10, v[108:109] offset:8
    ds_write_b64 v10, v[120:121] offset:1032
    ds_write_b64 v10, v[80:81] offset:2056
    ds_write_b64 v10, v[116:117] offset:3080
    s_add_u32 s20, s84, 0x680000
    s_addc_u32 s21, s85, 0
    s_mov_b32 s22, 0x508000
    s_mov_b32 s23, 0x00020000
    s_mul_i32 s8, s4, 20608
    s_add_u32 s9, s8, 5120
    s_add_u32 s10, s8, 10240
    s_add_u32 s11, s8, 15360
    s_waitcnt lgkmcnt(0)
    s_barrier
    ds_read_b128 v[48:51], v9 offset:0
    ds_read_b128 v[52:55], v9 offset:1024
    ds_read_b128 v[56:59], v9 offset:2048
    ds_read_b128 v[60:63], v9 offset:3072
    s_waitcnt lgkmcnt(3)
    v_bfi_b32 v48, v31, s66, v48
    v_bfi_b32 v49, v31, s67, v49
    v_bfi_b32 v50, v31, s82, v50
    v_bfi_b32 v51, v31, s83, v51
    buffer_store_dwordx4 v[48:51], v29, s[20:23], s8 offen sc1
    s_waitcnt lgkmcnt(2)
    v_bfi_b32 v52, v31, s66, v52
    v_bfi_b32 v53, v31, s67, v53
    v_bfi_b32 v54, v31, s82, v54
    v_bfi_b32 v55, v31, s83, v55
    buffer_store_dwordx4 v[52:55], v29, s[20:23], s9 offen sc1
    s_waitcnt lgkmcnt(1)
    v_bfi_b32 v56, v31, s66, v56
    v_bfi_b32 v57, v31, s67, v57
    v_bfi_b32 v58, v31, s82, v58
    v_bfi_b32 v59, v31, s83, v59
    buffer_store_dwordx4 v[56:59], v29, s[20:23], s10 offen sc1
    s_waitcnt lgkmcnt(0)
    v_bfi_b32 v60, v31, s66, v60
    v_bfi_b32 v61, v31, s67, v61
    v_bfi_b32 v62, v31, s82, v62
    v_bfi_b32 v63, v31, s83, v63
    buffer_store_dwordx4 v[60:63], v29, s[20:23], s11 offen sc1
    s_nop 1
    s_cmp_lt_u32 s5, 32
    s_cbranch_scc1 L_nd2
    s_waitcnt vmcnt(0)
    s_nop 1
L_nd2:
    v_mul_u32_u24 v64, 1, v1
    v_cvt_f32_u32 v64, v64
    v_mul_f32 v64, 0x3acccccd, v64
    v_fract_f32 v64, v64
    v_cos_f32 v68, v64
    v_sin_f32 v69, v64
    v_mul_u32_u24 v64, 2, v1
    v_cvt_f32_u32 v64, v64
    v_mul_f32 v64, 0x3acccccd, v64
    v_fract_f32 v64, v64
    v_cos_f32 v70, v64
    v_sin_f32 v71, v64
    v_mul_u32_u24 v64, 3, v1
    v_cvt_f32_u32 v64, v64
    v_mul_f32 v64, 0x3acccccd, v64
    v_fract_f32 v64, v64
    v_cos_f32 v72, v64
    v_sin_f32 v73, v64
    v_mul_u32_u24 v64, 4, v1
    v_cvt_f32_u32 v64, v64
    v_mul_f32 v64, 0x3acccccd, v64
    v_fract_f32 v64, v64
    v_cos_f32 v74, v64
    v_sin_f32 v75, v64
    v_mul_u32_u24 v64, 5, v1
    v_cvt_f32_u32 v64, v64
    v_mul_f32 v64, 0x3acccccd, v64
    v_fract_f32 v64, v64
    v_cos_f32 v76, v64
    v_sin_f32 v77, v64
    v_mul_u32_u24 v64, 6, v1
    v_cvt_f32_u32 v64, v64
    v_mul_f32 v64, 0x3acccccd, v64
    v_fract_f32 v64, v64
    v_cos_f32 v78, v64
    v_sin_f32 v79, v64
    v_mul_u32_u24 v64, 7, v1
    v_cvt_f32_u32 v64, v64
    v_mul_f32 v64, 0x3acccccd, v64
    v_fract_f32 v64, v64
    v_cos_f32 v80, v64
    v_sin_f32 v81, v64
    v_mul_u32_u24 v64, 8, v1
    v_cvt_f32_u32 v64, v64
    v_mul_f32 v64, 0x3acccccd, v64
    v_fract_f32 v64, v64
    v_cos_f32 v82, v64
    v_sin_f32 v83, v64
    v_mul_u32_u24 v64, 9, v1
    v_cvt_f32_u32 v64, v64
    v_mul_f32 v64, 0x3acccccd, v64
    v_fract_f32 v64, v64
    v_cos_f32 v84, v64
    v_sin_f32 v85, v64
    v_lshlrev_b32 v86, 16, v16
    v_and_b32 v87, s15, v16
    v_lshlrev_b32 v88, 16, v17
    v_and_b32 v89, s15, v17
    v_lshlrev_b32 v90, 16, v18
    v_and_b32 v91, s15, v18
    v_lshlrev_b32 v92, 16, v19
    v_and_b32 v93, s15, v19
    v_lshlrev_b32 v94, 16, v20
    v_and_b32 v95, s15, v20
    v_lshlrev_b32 v96, 16, v21
    v_and_b32 v97, s15, v21
    v_lshlrev_b32 v98, 16, v22
    v_and_b32 v99, s15, v22
    v_lshlrev_b32 v100, 16, v23
    v_and_b32 v101, s15, v23
    v_lshlrev_b32 v102, 16, v24
    v_and_b32 v103, s15, v24
    v_lshlrev_b32 v104, 16, v25
    v_and_b32 v105, s15, v25
    v_lshlrev_b32 v65, 2, v1
    v_add_u32 v65, 50352, v65
    s_mul_i32 s14, s3, 2560
    v_lshlrev_b32 v66, 1, v1
    v_add_u32 v66, s14, v66
    v_add_u32 v67, 130736, v66
    s_waitcnt lgkmcnt(0)
    s_barrier
    ds_read2st64_b32 v[106:107], v65 offset0:0 offset1:10
    ds_read2st64_b32 v[108:109], v65 offset0:1 offset1:11
    ds_read2st64_b32 v[110:111], v65 offset0:2 offset1:12
    ds_read2st64_b32 v[112:113], v65 offset0:3 offset1:13
    ds_read2st64_b32 v[114:115], v65 offset0:4 offset1:14
    ds_read2st64_b32 v[116:117], v65 offset0:5 offset1:15
    ds_read2st64_b32 v[118:119], v65 offset0:6 offset1:16
    ds_read2st64_b32 v[120:121], v65 offset0:7 offset1:17
    ds_read2st64_b32 v[122:123], v65 offset0:8 offset1:18
    ds_read2st64_b32 v[124:125], v65 offset0:9 offset1:19
    ds_read2st64_b32 v[146:147], v65 offset0:40 offset1:41
    ds_read2st64_b32 v[148:149], v65 offset0:42 offset1:43
    ds_read2st64_b32 v[150:151], v65 offset0:44 offset1:45
    ds_read2st64_b32 v[152:153], v65 offset0:46 offset1:47
    ds_read2st64_b32 v[154:155], v65 offset0:48 offset1:49
    s_waitcnt lgkmcnt(5)
    ds_read2st64_b32 v[126:127], v65 offset0:20 offset1:30
    ds_read2st64_b32 v[128:129], v65 offset0:21 offset1:31
    ds_read2st64_b32 v[130:131], v65 offset0:22 offset1:32
    ds_read2st64_b32 v[132:133], v65 offset0:23 offset1:33
    ds_read2st64_b32 v[134:135], v65 offset0:24 offset1:34
    ds_read2st64_b32 v[136:137], v65 offset0:25 offset1:35
    ds_read2st64_b32 v[138:139], v65 offset0:26 offset1:36
    ds_read2st64_b32 v[140:141], v65 offset0:27 offset1:37
    ds_read2st64_b32 v[142:143], v65 offset0:28 offset1:38
    ds_read2st64_b32 v[144:145], v65 offset0:29 offset1:39
    v_lshrrev_b32 v156, 16, v106
    v_lshrrev_b32 v157, 16, v108
    v_lshrrev_b32 v158, 16, v110
    v_lshrrev_b32 v159, 16, v112
    v_lshrrev_b32 v160, 16, v114
    v_lshrrev_b32 v161, 16, v116
    v_lshrrev_b32 v162, 16, v118
    v_lshrrev_b32 v163, 16, v120
    v_lshrrev_b32 v164, 16, v122
    v_lshrrev_b32 v165, 16, v124
    s_waitcnt lgkmcnt(10)
    v_mul_f32 v187, v107, v146
    v_fmac_f32 v187, v109, v147
    v_fmac_f32 v187, v111, v148
    v_fmac_f32 v187, v113, v149
    v_fmac_f32 v187, v115, v150
    v_fmac_f32 v187, v117, v151
    v_fmac_f32 v187, v119, v152
    v_fmac_f32 v187, v121, v153
    v_fmac_f32 v187, v123, v154
    v_fmac_f32 v187, v125, v155
    s_waitcnt lgkmcnt(0)
    v_mul_f32 v146, v126, v146
    v_mul_f32 v147, v128, v147
    v_mul_f32 v148, v130, v148
    v_mul_f32 v149, v132, v149
    v_mul_f32 v150, v134, v150
    v_mul_f32 v151, v136, v151
    v_mul_f32 v152, v138, v152
    v_mul_f32 v153, v140, v153
    v_mul_f32 v154, v142, v154
    v_mul_f32 v155, v144, v155
    v_pk_add_f32 v[188:189], v[146:147], v[148:149]
    v_pk_add_f32 v[188:189], v[188:189], v[150:151]
    v_pk_add_f32 v[188:189], v[188:189], v[152:153]
    v_pk_add_f32 v[188:189], v[188:189], v[154:155]
    v_add_f32 v186, v188, v189
    v_lshrrev_b32 v166, 16, v126
    v_lshrrev_b32 v167, 16, v128
    v_permlane32_swap_b32 v186, v187
    v_add_f32 v186, v186, v187
    v_mov_b32 v188, v186
    v_lshrrev_b32 v168, 16, v130
    v_lshrrev_b32 v169, 16, v132
    v_permlane16_swap_b32 v186, v188
    v_add_f32 v186, v186, v188
    v_lshrrev_b32 v170, 16, v134
    v_lshrrev_b32 v171, 16, v136
    v_add_f32_dpp v186, v186, v186 row_ror:8 row_mask:0xf bank_mask:0xf
    v_lshrrev_b32 v172, 16, v138
    v_lshrrev_b32 v173, 16, v140
    v_add_f32_dpp v186, v186, v186 row_ror:4 row_mask:0xf bank_mask:0xf
    v_lshrrev_b32 v174, 16, v142
    v_lshrrev_b32 v175, 16, v144
    v_add_f32_dpp v186, v186, v186 row_ror:2 row_mask:0xf bank_mask:0xf
    v_lshrrev_b32 v176, 16, v127
    v_lshrrev_b32 v177, 16, v129
    v_add_f32_dpp v186, v186, v186 row_ror:1 row_mask:0xf bank_mask:0xf
    v_mov_b32 v187, v186
    v_lshrrev_b32 v178, 16, v131
    v_lshrrev_b32 v179, 16, v133
    v_permlane32_swap_b32 v186, v187
    v_lshrrev_b32 v180, 16, v135
    v_lshrrev_b32 v181, 16, v137
    v_lshrrev_b32 v182, 16, v139
    v_lshrrev_b32 v183, 16, v141
    v_lshrrev_b32 v184, 16, v143
    v_lshrrev_b32 v185, 16, v145
    s_add_u32 s20, s84, 0x680000
    s_addc_u32 s21, s85, 0
    s_mov_b32 s22, 0x508000
    s_mov_b32 s23, 0x00020000
    s_mul_i32 s8, s4, 80
    s_add_u32 s9, s8, 1318912
    s_add_u32 s10, s8, 2637824
    s_add_u32 s11, s8, 3956736
    s_mov_b32 s7, 0
    s_nop 1
Lp9:
    buffer_load_dwordx4 v[48:51], v28, s[20:23], s8 offen sc1
    buffer_load_dwordx4 v[52:55], v28, s[20:23], s9 offen sc1
    buffer_load_dwordx4 v[56:59], v28, s[20:23], s10 offen sc1
    buffer_load_dwordx4 v[60:63], v28, s[20:23], s11 offen sc1
    s_add_u32 s7, s7, 1
    s_waitcnt vmcnt(3)
    v_xor_b32 v15, s66, v48
    v_bitop3_b32 v15, v49, s67, v15 bitop3:0xbe
    v_bitop3_b32 v15, v50, s82, v15 bitop3:0xbe
    v_bitop3_b32 v15, v51, s83, v15 bitop3:0xbe
    s_waitcnt vmcnt(2)
    v_bitop3_b32 v15, v52, s66, v15 bitop3:0xbe
    v_bitop3_b32 v15, v53, s67, v15 bitop3:0xbe
    v_bitop3_b32 v15, v54, s82, v15 bitop3:0xbe
    v_bitop3_b32 v15, v55, s83, v15 bitop3:0xbe
    s_waitcnt vmcnt(1)
    v_bitop3_b32 v15, v56, s66, v15 bitop3:0xbe
    v_bitop3_b32 v15, v57, s67, v15 bitop3:0xbe
    v_bitop3_b32 v15, v58, s82, v15 bitop3:0xbe
    v_bitop3_b32 v15, v59, s83, v15 bitop3:0xbe
    s_waitcnt vmcnt(0)
    v_bitop3_b32 v15, v60, s66, v15 bitop3:0xbe
    v_bitop3_b32 v15, v61, s67, v15 bitop3:0xbe
    v_bitop3_b32 v15, v62, s82, v15 bitop3:0xbe
    v_bitop3_b32 v15, v63, s83, v15 bitop3:0xbe
    v_and_b32 v15, v31, v15
    v_cmp_ne_u32 vcc, 0, v15
    s_cmp_ge_u32 s7, 20000
    s_cbranch_scc1 Lp10
    s_and_b64 exec, exec, vcc
    s_cbranch_execnz Lp9
    s_nop 1
Lp10:
    s_mov_b64 exec, -1
    v_permlane32_swap_b32 v48, v50
    v_permlane32_swap_b32 v49, v51
    v_permlane32_swap_b32 v52, v54
    v_permlane32_swap_b32 v53, v55
    v_permlane32_swap_b32 v56, v58
    v_permlane32_swap_b32 v57, v59
    v_permlane32_swap_b32 v60, v62
    v_permlane32_swap_b32 v61, v63
    s_mov_b64 exec, s[86:87]
    v_pk_mul_f32 v[196:197], v[62:63], s[46:47] op_sel:[0,0] op_sel_hi:[1,0]
    v_pk_fma_f32 v[190:191], v[62:63], s[46:47], v[196:197] op_sel:[1,1,0] op_sel_hi:[0,1,1] neg_lo:[1,0,0]
    v_pk_mul_f32 v[196:197], v[60:61], s[48:49] op_sel:[0,0] op_sel_hi:[1,0]
    v_pk_fma_f32 v[192:193], v[60:61], s[48:49], v[196:197] op_sel:[1,1,0] op_sel_hi:[0,1,1] neg_lo:[1,0,0]
    v_pk_mul_f32 v[196:197], v[58:59], s[50:51] op_sel:[0,0] op_sel_hi:[1,0]
    v_pk_fma_f32 v[194:195], v[58:59], s[50:51], v[196:197] op_sel:[1,1,0] op_sel_hi:[0,1,1] neg_lo:[1,0,0]
    s_mov_b64 exec, -1
    v_pk_mul_f32 v[196:197], v[50:51], s[46:47] op_sel:[0,0] op_sel_hi:[1,0]
    v_pk_fma_f32 v[50:51], v[50:51], s[46:47], v[196:197] op_sel:[1,1,0] op_sel_hi:[0,1,1] neg_lo:[1,0,0]
    v_pk_mul_f32 v[196:197], v[52:53], s[48:49] op_sel:[0,0] op_sel_hi:[1,0]
    v_pk_fma_f32 v[52:53], v[52:53], s[48:49], v[196:197] op_sel:[1,1,0] op_sel_hi:[0,1,1] neg_lo:[1,0,0]
    v_pk_mul_f32 v[196:197], v[54:55], s[50:51] op_sel:[0,0] op_sel_hi:[1,0]
    v_pk_fma_f32 v[54:55], v[54:55], s[50:51], v[196:197] op_sel:[1,1,0] op_sel_hi:[0,1,1] neg_lo:[1,0,0]
    v_pk_mul_f32 v[196:197], v[56:57], s[52:53] op_sel:[0,0] op_sel_hi:[1,0]
    v_pk_fma_f32 v[56:57], v[56:57], s[52:53], v[196:197] op_sel:[1,1,0] op_sel_hi:[0,1,1] neg_lo:[1,0,0]
    v_pk_mul_f32 v[196:197], v[58:59], s[54:55] op_sel:[0,0] op_sel_hi:[1,0]
    v_pk_fma_f32 v[58:59], v[58:59], s[54:55], v[196:197] op_sel:[1,1,0] op_sel_hi:[0,1,1] neg_lo:[1,0,0]
    v_pk_mul_f32 v[196:197], v[60:61], s[56:57] op_sel:[0,0] op_sel_hi:[1,0]
    v_pk_fma_f32 v[60:61], v[60:61], s[56:57], v[196:197] op_sel:[1,1,0] op_sel_hi:[0,1,1] neg_lo:[1,0,0]
    v_pk_mul_f32 v[196:197], v[62:63], s[70:71] op_sel:[0,0] op_sel_hi:[1,0]
    v_pk_fma_f32 v[62:63], v[62:63], s[70:71], v[196:197] op_sel:[1,1,0] op_sel_hi:[0,1,1] neg_lo:[1,0,0]
    s_mov_b64 exec, s[86:87]
    v_pk_add_f32 v[62:63], v[50:51], v[190:191] op_sel:[0,1] op_sel_hi:[1,0] neg_hi:[1,0]
    v_pk_add_f32 v[50:51], v[50:51], v[190:191] op_sel:[0,1] op_sel_hi:[1,0] neg_lo:[0,1]
    v_pk_add_f32 v[60:61], v[52:53], v[192:193] op_sel:[0,1] op_sel_hi:[1,0] neg_hi:[1,0]
    v_pk_add_f32 v[52:53], v[52:53], v[192:193] op_sel:[0,1] op_sel_hi:[1,0] neg_lo:[0,1]
    v_pk_add_f32 v[58:59], v[54:55], v[194:195] op_sel:[0,1] op_sel_hi:[1,0] neg_hi:[1,0]
    v_pk_add_f32 v[54:55], v[54:55], v[194:195] op_sel:[0,1] op_sel_hi:[1,0] neg_lo:[0,1]
    s_mov_b64 exec, -1
    v_pk_add_f32 v[194:195], v[48:49], v[56:57]
    v_pk_add_f32 v[192:193], v[48:49], v[56:57] neg_lo:[0,1] neg_hi:[0,1]
    v_pk_add_f32 v[190:191], v[50:51], v[58:59]
    v_pk_add_f32 v[196:197], v[50:51], v[58:59] neg_lo:[0,1] neg_hi:[0,1]
    v_pk_add_f32 v[216:217], v[52:53], v[60:61]
    v_pk_add_f32 v[218:219], v[52:53], v[60:61] neg_lo:[0,1] neg_hi:[0,1]
    v_pk_add_f32 v[220:221], v[54:55], v[62:63]
    v_pk_add_f32 v[222:223], v[54:55], v[62:63] neg_lo:[0,1] neg_hi:[0,1]
    v_pk_add_f32 v[62:63], v[194:195], v[216:217]
    v_pk_add_f32 v[60:61], v[194:195], v[216:217] neg_lo:[0,1] neg_hi:[0,1]
    v_pk_add_f32 v[58:59], v[190:191], v[220:221]
    v_pk_add_f32 v[56:57], v[190:191], v[220:221] neg_lo:[0,1] neg_hi:[0,1]
    v_pk_add_f32 v[220:221], v[62:63], v[58:59]
    v_pk_add_f32 v[216:217], v[62:63], v[58:59] neg_lo:[0,1] neg_hi:[0,1]
    v_pk_add_f32 v[190:191], v[60:61], v[56:57] op_sel:[0,1] op_sel_hi:[1,0] neg_lo:[0,1]
    v_pk_add_f32 v[194:195], v[60:61], v[56:57] op_sel:[0,1] op_sel_hi:[1,0] neg_hi:[0,1]
    v_pk_add_f32 v[56:57], v[196:197], v[196:197] op_sel:[0,1] op_sel_hi:[1,0] neg_lo:[0,1]
    v_pk_add_f32 v[58:59], v[222:223], v[222:223] op_sel:[0,1] op_sel_hi:[1,0] neg_lo:[1,1] neg_hi:[1,0]
    v_pk_add_f32 v[60:61], v[192:193], v[218:219] op_sel:[0,1] op_sel_hi:[1,0] neg_lo:[0,1]
    v_pk_add_f32 v[62:63], v[192:193], v[218:219] op_sel:[0,1] op_sel_hi:[1,0] neg_hi:[0,1]
    v_pk_add_f32 v[222:223], v[56:57], v[58:59]
    v_pk_add_f32 v[218:219], v[56:57], v[58:59] neg_lo:[0,1] neg_hi:[0,1]
    v_pk_fma_f32 v[58:59], v[222:223], s[32:33], v[60:61]
    v_pk_fma_f32 v[56:57], v[222:223], s[32:33], v[60:61] neg_lo:[1,0,0] neg_hi:[1,0,0]
    v_pk_fma_f32 v[196:197], v[218:219], s[32:33], v[62:63] op_sel:[1,0,0] op_sel_hi:[0,1,1] neg_lo:[1,0,0]
    v_pk_fma_f32 v[192:193], v[218:219], s[32:33], v[62:63] op_sel:[1,0,0] op_sel_hi:[0,1,1] neg_hi:[1,0,0]
    v_pk_add_f32 v[200:201], v[220:221], v[58:59] op_sel:[0,1] op_sel_hi:[1,0] neg_lo:[0,1]
    v_pk_add_f32 v[202:203], v[220:221], v[58:59] op_sel:[0,1] op_sel_hi:[1,0] neg_hi:[1,0]
    ds_write_b128 v26, v[200:203] offset:24320
    v_pk_add_f32 v[206:207], v[190:191], v[196:197] op_sel:[0,1] op_sel_hi:[1,0] neg_lo:[0,1]
    v_pk_add_f32 v[204:205], v[190:191], v[196:197] op_sel:[0,1] op_sel_hi:[1,0] neg_hi:[1,0]
    ds_write_b128 v26, v[204:207] offset:29472
    v_pk_add_f32 v[208:209], v[216:217], v[56:57] op_sel:[0,1] op_sel_hi:[1,0] neg_lo:[0,1]
    v_pk_add_f32 v[210:211], v[216:217], v[56:57] op_sel:[0,1] op_sel_hi:[1,0] neg_hi:[1,0]
    ds_write_b128 v26, v[208:211] offset:34624
    v_pk_add_f32 v[214:215], v[194:195], v[192:193] op_sel:[0,1] op_sel_hi:[1,0] neg_lo:[0,1]
    v_pk_add_f32 v[212:213], v[194:195], v[192:193] op_sel:[0,1] op_sel_hi:[1,0] neg_hi:[1,0]
    ds_write_b128 v26, v[212:215] offset:39776
    v_xor_b32 v15, 8, v5
    s_waitcnt lgkmcnt(0)
    s_barrier
    ds_read_b64 v[62:63], v5 offset:0
    ds_read_b64 v[54:55], v6 offset:1920
    s_mov_b64 exec, s[12:13]
    ds_read_b64 v[54:55], v15
    s_mov_b64 exec, -1
    ds_read_b64 v[60:61], v5 offset:640
    ds_read_b64 v[52:53], v6 offset:1280
    ds_read_b64 v[58:59], v5 offset:1280
    ds_read_b64 v[50:51], v6 offset:640
    ds_read_b64 v[56:57], v5 offset:1920
    ds_read_b64 v[48:49], v6 offset:0
    s_waitcnt lgkmcnt(6)
    s_mov_b64 exec, s[12:13]
    v_pk_add_f32 v[190:191], v[62:63], v[54:55] op_sel:[1,1] op_sel_hi:[0,0] neg_lo:[0,1] neg_hi:[1,0]
    v_pk_add_f32 v[62:63], v[62:63], v[54:55]
    v_pk_mov_b32 v[54:55], v[190:191], v[190:191] op_sel:[0,1]
    s_mov_b64 exec, -1
    v_pk_add_f32 v[190:191], v[62:63], v[54:55]
    v_pk_add_f32 v[192:193], v[62:63], v[54:55] neg_lo:[0,1] neg_hi:[0,1]
    s_waitcnt lgkmcnt(4)
    v_pk_add_f32 v[194:195], v[60:61], v[52:53]
    v_pk_add_f32 v[196:197], v[60:61], v[52:53] neg_lo:[0,1] neg_hi:[0,1]
    s_waitcnt lgkmcnt(2)
    v_pk_add_f32 v[198:199], v[58:59], v[50:51]
    v_pk_add_f32 v[200:201], v[58:59], v[50:51] neg_lo:[0,1] neg_hi:[0,1]
    s_waitcnt lgkmcnt(0)
    v_pk_add_f32 v[202:203], v[56:57], v[48:49]
    v_pk_add_f32 v[204:205], v[56:57], v[48:49] neg_lo:[0,1] neg_hi:[0,1]
    v_pk_add_f32 v[48:49], v[190:191], v[198:199]
    v_pk_add_f32 v[50:51], v[190:191], v[198:199] neg_lo:[0,1] neg_hi:[0,1]
    v_pk_add_f32 v[52:53], v[194:195], v[202:203]
    v_pk_add_f32 v[54:55], v[194:195], v[202:203] neg_lo:[0,1] neg_hi:[0,1]
    v_pk_add_f32 v[202:203], v[48:49], v[52:53]
    v_pk_add_f32 v[198:199], v[48:49], v[52:53] neg_lo:[0,1] neg_hi:[0,1]
    v_pk_add_f32 v[194:195], v[50:51], v[54:55] op_sel:[0,1] op_sel_hi:[1,0] neg_lo:[0,1]
    v_pk_add_f32 v[190:191], v[50:51], v[54:55] op_sel:[0,1] op_sel_hi:[1,0] neg_hi:[0,1]
    v_pk_add_f32 v[54:55], v[196:197], v[196:197] op_sel:[0,1] op_sel_hi:[1,0] neg_lo:[0,1]
    v_pk_add_f32 v[52:53], v[204:205], v[204:205] op_sel:[0,1] op_sel_hi:[1,0] neg_lo:[1,1] neg_hi:[1,0]
    v_pk_add_f32 v[50:51], v[192:193], v[200:201] op_sel:[0,1] op_sel_hi:[1,0] neg_lo:[0,1]
    v_pk_add_f32 v[48:49], v[192:193], v[200:201] op_sel:[0,1] op_sel_hi:[1,0] neg_hi:[0,1]
    v_pk_add_f32 v[204:205], v[54:55], v[52:53]
    v_pk_add_f32 v[200:201], v[54:55], v[52:53] neg_lo:[0,1] neg_hi:[0,1]
    v_pk_fma_f32 v[52:53], v[204:205], s[32:33], v[50:51]
    v_pk_fma_f32 v[54:55], v[204:205], s[32:33], v[50:51] neg_lo:[1,0,0] neg_hi:[1,0,0]
    v_pk_fma_f32 v[196:197], v[200:201], s[32:33], v[48:49] op_sel:[1,0,0] op_sel_hi:[0,1,1] neg_lo:[1,0,0]
    v_pk_fma_f32 v[192:193], v[200:201], s[32:33], v[48:49] op_sel:[1,0,0] op_sel_hi:[0,1,1] neg_hi:[1,0,0]
    ds_write_b64 v4, v[202:203] offset:0
    ds_write_b64 v4, v[52:53] offset:8
    ds_write_b64 v4, v[194:195] offset:16
    ds_write_b64 v4, v[196:197] offset:24
    ds_write_b64 v4, v[198:199] offset:32
    ds_write_b64 v4, v[54:55] offset:40
    ds_write_b64 v4, v[190:191] offset:48
    ds_write_b64 v4, v[192:193] offset:56
    ds_read_b64 v[192:193], v3 offset:0
    ds_read_b64 v[196:197], v3 offset:288
    ds_read_b64 v[190:191], v3 offset:72
    ds_read_b64 v[194:195], v3 offset:360
    ds_read_b64 v[54:55], v3 offset:144
    ds_read_b64 v[52:53], v3 offset:432
    ds_read_b64 v[198:199], v3 offset:216
    ds_read_b64 v[202:203], v3 offset:504
    s_waitcnt lgkmcnt(6)
    v_pk_mul_f32 v[200:201], v[196:197], v[38:39] op_sel:[0,0] op_sel_hi:[1,0]
    v_pk_fma_f32 v[196:197], v[196:197], v[38:39], v[200:201] op_sel:[1,1,0] op_sel_hi:[0,1,1] neg_lo:[1,0,0]
    v_pk_add_f32 v[200:201], v[192:193], v[196:197]
    v_pk_add_f32 v[204:205], v[192:193], v[196:197] neg_lo:[0,1] neg_hi:[0,1]
    s_waitcnt lgkmcnt(4)
    v_pk_mul_f32 v[48:49], v[190:191], v[32:33] op_sel:[0,0] op_sel_hi:[1,0]
    v_pk_fma_f32 v[190:191], v[190:191], v[32:33], v[48:49] op_sel:[1,1,0] op_sel_hi:[0,1,1] neg_lo:[1,0,0]
    v_pk_mul_f32 v[48:49], v[194:195], v[40:41] op_sel:[0,0] op_sel_hi:[1,0]
    v_pk_fma_f32 v[194:195], v[194:195], v[40:41], v[48:49] op_sel:[1,1,0] op_sel_hi:[0,1,1] neg_lo:[1,0,0]
    v_pk_add_f32 v[48:49], v[190:191], v[194:195]
    v_pk_add_f32 v[50:51], v[190:191], v[194:195] neg_lo:[0,1] neg_hi:[0,1]
    s_waitcnt lgkmcnt(2)
    v_pk_mul_f32 v[56:57], v[54:55], v[34:35] op_sel:[0,0] op_sel_hi:[1,0]
    v_pk_fma_f32 v[54:55], v[54:55], v[34:35], v[56:57] op_sel:[1,1,0] op_sel_hi:[0,1,1] neg_lo:[1,0,0]
    v_pk_mul_f32 v[56:57], v[52:53], v[42:43] op_sel:[0,0] op_sel_hi:[1,0]
    v_pk_fma_f32 v[52:53], v[52:53], v[42:43], v[56:57] op_sel:[1,1,0] op_sel_hi:[0,1,1] neg_lo:[1,0,0]
    v_pk_add_f32 v[56:57], v[54:55], v[52:53]
    v_pk_add_f32 v[58:59], v[54:55], v[52:53] neg_lo:[0,1] neg_hi:[0,1]
    s_waitcnt lgkmcnt(0)
    v_pk_mul_f32 v[60:61], v[198:199], v[36:37] op_sel:[0,0] op_sel_hi:[1,0]
    v_pk_fma_f32 v[198:199], v[198:199], v[36:37], v[60:61] op_sel:[1,1,0] op_sel_hi:[0,1,1] neg_lo:[1,0,0]
    v_pk_mul_f32 v[60:61], v[202:203], v[44:45] op_sel:[0,0] op_sel_hi:[1,0]
    v_pk_fma_f32 v[202:203], v[202:203], v[44:45], v[60:61] op_sel:[1,1,0] op_sel_hi:[0,1,1] neg_lo:[1,0,0]
    v_pk_add_f32 v[60:61], v[198:199], v[202:203]
    v_pk_add_f32 v[62:63], v[198:199], v[202:203] neg_lo:[0,1] neg_hi:[0,1]
    v_pk_add_f32 v[202:203], v[200:201], v[56:57]
    v_pk_add_f32 v[52:53], v[200:201], v[56:57] neg_lo:[0,1] neg_hi:[0,1]
    v_pk_add_f32 v[194:195], v[48:49], v[60:61]
    v_pk_add_f32 v[196:197], v[48:49], v[60:61] neg_lo:[0,1] neg_hi:[0,1]
    v_pk_add_f32 v[60:61], v[202:203], v[194:195]
    v_pk_add_f32 v[56:57], v[202:203], v[194:195] neg_lo:[0,1] neg_hi:[0,1]
    v_pk_add_f32 v[48:49], v[52:53], v[196:197] op_sel:[0,1] op_sel_hi:[1,0] neg_lo:[0,1]
    v_pk_add_f32 v[200:201], v[52:53], v[196:197] op_sel:[0,1] op_sel_hi:[1,0] neg_hi:[0,1]
    v_pk_add_f32 v[196:197], v[50:51], v[50:51] op_sel:[0,1] op_sel_hi:[1,0] neg_lo:[0,1]
    v_pk_add_f32 v[194:195], v[62:63], v[62:63] op_sel:[0,1] op_sel_hi:[1,0] neg_lo:[1,1] neg_hi:[1,0]
    v_pk_add_f32 v[52:53], v[204:205], v[58:59] op_sel:[0,1] op_sel_hi:[1,0] neg_lo:[0,1]
    v_pk_add_f32 v[202:203], v[204:205], v[58:59] op_sel:[0,1] op_sel_hi:[1,0] neg_hi:[0,1]
    v_pk_add_f32 v[62:63], v[196:197], v[194:195]
    v_pk_add_f32 v[58:59], v[196:197], v[194:195] neg_lo:[0,1] neg_hi:[0,1]
    v_pk_fma_f32 v[194:195], v[62:63], s[32:33], v[52:53]
    v_pk_fma_f32 v[196:197], v[62:63], s[32:33], v[52:53] neg_lo:[1,0,0] neg_hi:[1,0,0]
    v_pk_fma_f32 v[50:51], v[58:59], s[32:33], v[202:203] op_sel:[1,0,0] op_sel_hi:[0,1,1] neg_lo:[1,0,0]
    v_pk_fma_f32 v[204:205], v[58:59], s[32:33], v[202:203] op_sel:[1,0,0] op_sel_hi:[0,1,1] neg_hi:[1,0,0]
    ds_write_b64 v3, v[60:61] offset:0
    ds_write_b64 v3, v[194:195] offset:64
    ds_write_b64 v3, v[48:49] offset:128
    ds_write_b64 v3, v[50:51] offset:192
    ds_write_b64 v3, v[56:57] offset:256
    ds_write_b64 v3, v[196:197] offset:320
    ds_write_b64 v3, v[200:201] offset:384
    ds_write_b64 v3, v[204:205] offset:448
    s_waitcnt lgkmcnt(0)
    s_barrier
    s_cmp_eq_u32 s3, 4
    s_cbranch_scc1 L_w4b
    ds_read_b64 v[62:63], v2 offset:0
    ds_read_b64 v[60:61], v2 offset:2432
    ds_read_b64 v[58:59], v2 offset:4864
    ds_read_b64 v[56:57], v2 offset:7296
    ds_read_b64 v[54:55], v2 offset:9728
    ds_read_b64 v[52:53], v2 offset:12160
    ds_read_b64 v[50:51], v2 offset:14592
    ds_read_b64 v[48:49], v2 offset:17024
    ds_read_b64 v[190:191], v2 offset:19456
    ds_read_b64 v[192:193], v2 offset:21888
    v_mov_b32 v194, 0x3acccccd
    v_mov_b32 v195, 0x3acccccd
    s_waitcnt lgkmcnt(8)
    v_pk_mul_f32 v[196:197], v[60:61], v[68:69] op_sel:[0,0] op_sel_hi:[1,0]
    v_pk_fma_f32 v[60:61], v[60:61], v[68:69], v[196:197] op_sel:[1,1,0] op_sel_hi:[0,1,1] neg_lo:[1,0,0]
    s_waitcnt lgkmcnt(7)
    v_pk_mul_f32 v[196:197], v[58:59], v[70:71] op_sel:[0,0] op_sel_hi:[1,0]
    v_pk_fma_f32 v[58:59], v[58:59], v[70:71], v[196:197] op_sel:[1,1,0] op_sel_hi:[0,1,1] neg_lo:[1,0,0]
    s_waitcnt lgkmcnt(6)
    v_pk_mul_f32 v[196:197], v[56:57], v[72:73] op_sel:[0,0] op_sel_hi:[1,0]
    v_pk_fma_f32 v[56:57], v[56:57], v[72:73], v[196:197] op_sel:[1,1,0] op_sel_hi:[0,1,1] neg_lo:[1,0,0]
    s_waitcnt lgkmcnt(5)
    v_pk_mul_f32 v[196:197], v[54:55], v[74:75] op_sel:[0,0] op_sel_hi:[1,0]
    v_pk_fma_f32 v[54:55], v[54:55], v[74:75], v[196:197] op_sel:[1,1,0] op_sel_hi:[0,1,1] neg_lo:[1,0,0]
    s_waitcnt lgkmcnt(4)
    v_pk_mul_f32 v[196:197], v[52:53], v[76:77] op_sel:[0,0] op_sel_hi:[1,0]
    v_pk_fma_f32 v[52:53], v[52:53], v[76:77], v[196:197] op_sel:[1,1,0] op_sel_hi:[0,1,1] neg_lo:[1,0,0]
    s_waitcnt lgkmcnt(3)
    v_pk_mul_f32 v[196:197], v[50:51], v[78:79] op_sel:[0,0] op_sel_hi:[1,0]
    v_pk_fma_f32 v[50:51], v[50:51], v[78:79], v[196:197] op_sel:[1,1,0] op_sel_hi:[0,1,1] neg_lo:[1,0,0]
    s_waitcnt lgkmcnt(2)
    v_pk_mul_f32 v[196:197], v[48:49], v[80:81] op_sel:[0,0] op_sel_hi:[1,0]
    v_pk_fma_f32 v[48:49], v[48:49], v[80:81], v[196:197] op_sel:[1,1,0] op_sel_hi:[0,1,1] neg_lo:[1,0,0]
    s_waitcnt lgkmcnt(1)
    v_pk_mul_f32 v[196:197], v[190:191], v[82:83] op_sel:[0,0] op_sel_hi:[1,0]
    v_pk_fma_f32 v[190:191], v[190:191], v[82:83], v[196:197] op_sel:[1,1,0] op_sel_hi:[0,1,1] neg_lo:[1,0,0]
    s_waitcnt lgkmcnt(0)
    v_pk_mul_f32 v[196:197], v[192:193], v[84:85] op_sel:[0,0] op_sel_hi:[1,0]
    v_pk_fma_f32 v[192:193], v[192:193], v[84:85], v[196:197] op_sel:[1,1,0] op_sel_hi:[0,1,1] neg_lo:[1,0,0]
    v_pk_add_f32 v[196:197], v[62:63], v[52:53]
    v_pk_add_f32 v[198:199], v[62:63], v[52:53] neg_lo:[0,1] neg_hi:[0,1]
    v_pk_add_f32 v[52:53], v[58:59], v[48:49]
    v_pk_add_f32 v[62:63], v[58:59], v[48:49] neg_lo:[0,1] neg_hi:[0,1]
    v_pk_add_f32 v[48:49], v[54:55], v[192:193]
    v_pk_add_f32 v[58:59], v[54:55], v[192:193] neg_lo:[0,1] neg_hi:[0,1]
    v_pk_add_f32 v[192:193], v[50:51], v[60:61]
    v_pk_add_f32 v[54:55], v[50:51], v[60:61] neg_lo:[0,1] neg_hi:[0,1]
    v_pk_add_f32 v[60:61], v[190:191], v[56:57]
    v_pk_add_f32 v[50:51], v[190:191], v[56:57] neg_lo:[0,1] neg_hi:[0,1]
    v_pk_add_f32 v[56:57], v[52:53], v[60:61]
    v_pk_add_f32 v[190:191], v[48:49], v[192:193]
    v_pk_add_f32 v[200:201], v[52:53], v[60:61] neg_lo:[0,1] neg_hi:[0,1]
    v_pk_add_f32 v[202:203], v[48:49], v[192:193] neg_lo:[0,1] neg_hi:[0,1]
    v_pk_add_f32 v[60:61], v[56:57], v[190:191]
    v_pk_add_f32 v[192:193], v[196:197], v[60:61]
    v_pk_fma_f32 v[60:61], v[56:57], s[34:35], v[196:197]
    v_pk_fma_f32 v[60:61], v[190:191], s[36:37], v[60:61]
    v_pk_fma_f32 v[48:49], v[56:57], s[36:37], v[196:197]
    v_pk_fma_f32 v[48:49], v[190:191], s[34:35], v[48:49]
    v_pk_mul_f32 v[190:191], v[200:201], s[38:39]
    v_pk_fma_f32 v[190:191], v[202:203], s[40:41], v[190:191]
    v_pk_mul_f32 v[56:57], v[200:201], s[40:41]
    v_pk_fma_f32 v[56:57], v[202:203], s[38:39], v[56:57] neg_lo:[1,0,0] neg_hi:[1,0,0]
    v_pk_add_f32 v[202:203], v[60:61], v[190:191] op_sel:[0,1] op_sel_hi:[1,0] neg_lo:[0,1]
    v_pk_add_f32 v[200:201], v[60:61], v[190:191] op_sel:[0,1] op_sel_hi:[1,0] neg_hi:[0,1]
    v_pk_add_f32 v[196:197], v[48:49], v[56:57] op_sel:[0,1] op_sel_hi:[1,0] neg_lo:[0,1]
    v_pk_add_f32 v[52:53], v[48:49], v[56:57] op_sel:[0,1] op_sel_hi:[1,0] neg_hi:[0,1]
    v_pk_add_f32 v[56:57], v[62:63], v[50:51]
    v_pk_add_f32 v[190:191], v[58:59], v[54:55]
    v_pk_add_f32 v[48:49], v[62:63], v[50:51] neg_lo:[0,1] neg_hi:[0,1]
    v_pk_add_f32 v[60:61], v[58:59], v[54:55] neg_lo:[0,1] neg_hi:[0,1]
    v_pk_add_f32 v[50:51], v[56:57], v[190:191]
    v_pk_add_f32 v[54:55], v[198:199], v[50:51]
    v_pk_fma_f32 v[50:51], v[56:57], s[34:35], v[198:199]
    v_pk_fma_f32 v[50:51], v[190:191], s[36:37], v[50:51]
    v_pk_fma_f32 v[58:59], v[56:57], s[36:37], v[198:199]
    v_pk_fma_f32 v[58:59], v[190:191], s[34:35], v[58:59]
    v_pk_mul_f32 v[190:191], v[48:49], s[38:39]
    v_pk_fma_f32 v[190:191], v[60:61], s[40:41], v[190:191]
    v_pk_mul_f32 v[56:57], v[48:49], s[40:41]
    v_pk_fma_f32 v[56:57], v[60:61], s[38:39], v[56:57] neg_lo:[1,0,0] neg_hi:[1,0,0]
    v_pk_add_f32 v[60:61], v[50:51], v[190:191] op_sel:[0,1] op_sel_hi:[1,0] neg_lo:[0,1]
    v_pk_add_f32 v[48:49], v[50:51], v[190:191] op_sel:[0,1] op_sel_hi:[1,0] neg_hi:[0,1]
    v_pk_add_f32 v[198:199], v[58:59], v[56:57] op_sel:[0,1] op_sel_hi:[1,0] neg_lo:[0,1]
    v_pk_add_f32 v[62:63], v[58:59], v[56:57] op_sel:[0,1] op_sel_hi:[1,0] neg_hi:[0,1]
    v_cvt_pk_bf16_f32 v204, v192, v193
    v_cvt_pk_bf16_f32 v205, v60, v61
    v_cvt_pk_bf16_f32 v206, v196, v197
    v_cvt_pk_bf16_f32 v207, v62, v63
    v_cvt_pk_bf16_f32 v208, v200, v201
    v_cvt_pk_bf16_f32 v209, v54, v55
    v_cvt_pk_bf16_f32 v210, v202, v203
    v_cvt_pk_bf16_f32 v211, v198, v199
    v_cvt_pk_bf16_f32 v212, v52, v53
    v_cvt_pk_bf16_f32 v213, v48, v49
    v_dot2_f32_bf16 v192, v204, v156, 0
    v_dot2_f32_bf16 v193, v204, v106, 0
    v_dot2_f32_bf16 v60, v205, v157, 0
    v_dot2_f32_bf16 v61, v205, v108, 0
    v_dot2_f32_bf16 v196, v206, v158, 0
    v_dot2_f32_bf16 v197, v206, v110, 0
    v_dot2_f32_bf16 v62, v207, v159, 0
    v_dot2_f32_bf16 v63, v207, v112, 0
    v_dot2_f32_bf16 v200, v208, v160, 0
    v_dot2_f32_bf16 v201, v208, v114, 0
    v_dot2_f32_bf16 v54, v209, v161, 0
    v_dot2_f32_bf16 v55, v209, v116, 0
    v_dot2_f32_bf16 v202, v210, v162, 0
    v_dot2_f32_bf16 v203, v210, v118, 0
    v_dot2_f32_bf16 v198, v211, v163, 0
    v_dot2_f32_bf16 v199, v211, v120, 0
    v_dot2_f32_bf16 v52, v212, v164, 0
    v_dot2_f32_bf16 v53, v212, v122, 0
    v_dot2_f32_bf16 v48, v213, v165, 0
    v_dot2_f32_bf16 v49, v213, v124, 0
    v_cvt_pk_bf16_f32 v204, v192, v193
    v_cvt_pk_bf16_f32 v205, v60, v61
    v_cvt_pk_bf16_f32 v206, v196, v197
    v_cvt_pk_bf16_f32 v207, v62, v63
    v_cvt_pk_bf16_f32 v208, v200, v201
    v_cvt_pk_bf16_f32 v209, v54, v55
    v_cvt_pk_bf16_f32 v210, v202, v203
    v_cvt_pk_bf16_f32 v211, v198, v199
    v_cvt_pk_bf16_f32 v212, v52, v53
    v_cvt_pk_bf16_f32 v213, v48, v49
    v_dot2_f32_bf16 v192, v204, s44, v86
    v_dot2_f32_bf16 v193, v204, s45, v87
    v_dot2_f32_bf16 v60, v205, s44, v88
    v_dot2_f32_bf16 v61, v205, s45, v89
    v_dot2_f32_bf16 v196, v206, s44, v90
    v_dot2_f32_bf16 v197, v206, s45, v91
    v_dot2_f32_bf16 v62, v207, s44, v92
    v_dot2_f32_bf16 v63, v207, s45, v93
    v_dot2_f32_bf16 v200, v208, s44, v94
    v_dot2_f32_bf16 v201, v208, s45, v95
    v_dot2_f32_bf16 v54, v209, s44, v96
    v_dot2_f32_bf16 v55, v209, s45, v97
    v_dot2_f32_bf16 v202, v210, s44, v98
    v_dot2_f32_bf16 v203, v210, s45, v99
    v_dot2_f32_bf16 v198, v211, s44, v100
    v_dot2_f32_bf16 v199, v211, s45, v101
    v_dot2_f32_bf16 v52, v212, s44, v102
    v_dot2_f32_bf16 v53, v212, s45, v103
    v_dot2_f32_bf16 v48, v213, s44, v104
    v_dot2_f32_bf16 v49, v213, s45, v105
    v_cvt_pk_bf16_f32 v106, v192, v193
    v_cvt_pk_bf16_f32 v108, v60, v61
    v_cvt_pk_bf16_f32 v110, v196, v197
    v_cvt_pk_bf16_f32 v112, v62, v63
    v_cvt_pk_bf16_f32 v114, v200, v201
    v_cvt_pk_bf16_f32 v116, v54, v55
    v_cvt_pk_bf16_f32 v118, v202, v203
    v_cvt_pk_bf16_f32 v120, v198, v199
    v_cvt_pk_bf16_f32 v122, v52, v53
    v_cvt_pk_bf16_f32 v124, v48, v49
    v_lshlrev_b32 v192, 16, v106
    v_and_b32 v193, s15, v106
    v_lshlrev_b32 v60, 16, v108
    v_and_b32 v61, s15, v108
    v_readfirstlane_b32 s28, v192
    v_readfirstlane_b32 s29, v193
    v_lshlrev_b32 v196, 16, v110
    v_and_b32 v197, s15, v110
    v_lshlrev_b32 v62, 16, v112
    v_and_b32 v63, s15, v112
    v_lshlrev_b32 v200, 16, v114
    v_and_b32 v201, s15, v114
    v_lshlrev_b32 v54, 16, v116
    v_and_b32 v55, s15, v116
    v_lshlrev_b32 v202, 16, v118
    v_and_b32 v203, s15, v118
    v_lshlrev_b32 v198, 16, v120
    v_and_b32 v199, s15, v120
    v_lshlrev_b32 v52, 16, v122
    v_and_b32 v53, s15, v122
    v_lshlrev_b32 v48, 16, v124
    v_and_b32 v49, s15, v124
    v_pk_add_f32 v[86:87], v[192:193], s[28:29] neg_lo:[0,1] neg_hi:[0,1]
    v_pk_add_f32 v[88:89], v[60:61], s[28:29] neg_lo:[0,1] neg_hi:[0,1]
    v_pk_add_f32 v[90:91], v[196:197], s[28:29] neg_lo:[0,1] neg_hi:[0,1]
    v_mov_b32 v50, s28
    v_mov_b32 v51, s29
    v_pk_add_f32 v[92:93], v[62:63], s[28:29] neg_lo:[0,1] neg_hi:[0,1]
    v_pk_add_f32 v[94:95], v[200:201], s[28:29] neg_lo:[0,1] neg_hi:[0,1]
    v_pk_add_f32 v[96:97], v[54:55], s[28:29] neg_lo:[0,1] neg_hi:[0,1]
    v_pk_add_f32 v[98:99], v[202:203], s[28:29] neg_lo:[0,1] neg_hi:[0,1]
    v_permlane32_swap_b32 v50, v51
    v_pk_add_f32 v[100:101], v[198:199], s[28:29] neg_lo:[0,1] neg_hi:[0,1]
    v_pk_add_f32 v[102:103], v[52:53], s[28:29] neg_lo:[0,1] neg_hi:[0,1]
    v_pk_add_f32 v[104:105], v[48:49], s[28:29] neg_lo:[0,1] neg_hi:[0,1]
    v_pk_mul_f32 v[190:191], v[86:87], v[86:87]
    v_pk_mul_f32 v[58:59], v[86:87], v[146:147] op_sel:[0,0] op_sel_hi:[1,0]
    v_pk_add_f32 v[56:57], v[86:87], v[88:89]
    v_pk_fma_f32 v[190:191], v[88:89], v[88:89], v[190:191]
    v_pk_fma_f32 v[58:59], v[88:89], v[146:147], v[58:59] op_sel:[0,1,0] op_sel_hi:[1,1,1]
    v_pk_add_f32 v[56:57], v[56:57], v[90:91]
    v_pk_fma_f32 v[190:191], v[90:91], v[90:91], v[190:191]
    v_pk_fma_f32 v[58:59], v[90:91], v[148:149], v[58:59] op_sel:[0,0,0] op_sel_hi:[1,0,1]
    v_pk_add_f32 v[56:57], v[56:57], v[92:93]
    v_pk_fma_f32 v[190:191], v[92:93], v[92:93], v[190:191]
    v_pk_fma_f32 v[58:59], v[92:93], v[148:149], v[58:59] op_sel:[0,1,0] op_sel_hi:[1,1,1]
    v_pk_add_f32 v[56:57], v[56:57], v[94:95]
    v_pk_fma_f32 v[190:191], v[94:95], v[94:95], v[190:191]
    v_pk_fma_f32 v[58:59], v[94:95], v[150:151], v[58:59] op_sel:[0,0,0] op_sel_hi:[1,0,1]
    v_pk_add_f32 v[56:57], v[56:57], v[96:97]
    v_pk_fma_f32 v[190:191], v[96:97], v[96:97], v[190:191]
    v_pk_fma_f32 v[58:59], v[96:97], v[150:151], v[58:59] op_sel:[0,1,0] op_sel_hi:[1,1,1]
    v_pk_add_f32 v[56:57], v[56:57], v[98:99]
    v_pk_fma_f32 v[190:191], v[98:99], v[98:99], v[190:191]
    v_pk_fma_f32 v[58:59], v[98:99], v[152:153], v[58:59] op_sel:[0,0,0] op_sel_hi:[1,0,1]
    v_pk_add_f32 v[56:57], v[56:57], v[100:101]
    v_pk_fma_f32 v[190:191], v[100:101], v[100:101], v[190:191]
    v_pk_fma_f32 v[58:59], v[100:101], v[152:153], v[58:59] op_sel:[0,1,0] op_sel_hi:[1,1,1]
    v_pk_add_f32 v[56:57], v[56:57], v[102:103]
    v_pk_fma_f32 v[190:191], v[102:103], v[102:103], v[190:191]
    v_pk_fma_f32 v[58:59], v[102:103], v[154:155], v[58:59] op_sel:[0,0,0] op_sel_hi:[1,0,1]
    v_pk_add_f32 v[56:57], v[56:57], v[104:105]
    v_pk_fma_f32 v[190:191], v[104:105], v[104:105], v[190:191]
    v_pk_fma_f32 v[58:59], v[104:105], v[154:155], v[58:59] op_sel:[0,1,0] op_sel_hi:[1,1,1]
    v_permlane32_swap_b32 v56, v57
    v_permlane32_swap_b32 v190, v191
    v_permlane32_swap_b32 v58, v59
    v_add_f32 v56, v56, v57
    v_add_f32 v190, v190, v191
    v_add_f32 v58, v58, v59
    v_mov_b32 v204, v56
    v_mov_b32 v205, v190
    v_mov_b32 v206, v58
    v_permlane16_swap_b32 v56, v204
    v_permlane16_swap_b32 v190, v205
    v_permlane16_swap_b32 v58, v206
    v_add_f32 v56, v56, v204
    v_add_f32 v190, v190, v205
    v_add_f32 v58, v58, v206
    v_add_f32_dpp v56, v56, v56 row_ror:8 row_mask:0xf bank_mask:0xf
    v_add_f32_dpp v190, v190, v190 row_ror:8 row_mask:0xf bank_mask:0xf
    v_add_f32_dpp v58, v58, v58 row_ror:8 row_mask:0xf bank_mask:0xf
    v_add_f32_dpp v56, v56, v56 row_ror:4 row_mask:0xf bank_mask:0xf
    v_add_f32_dpp v190, v190, v190 row_ror:4 row_mask:0xf bank_mask:0xf
    v_add_f32_dpp v58, v58, v58 row_ror:4 row_mask:0xf bank_mask:0xf
    v_add_f32_dpp v56, v56, v56 row_ror:2 row_mask:0xf bank_mask:0xf
    v_add_f32_dpp v190, v190, v190 row_ror:2 row_mask:0xf bank_mask:0xf
    v_add_f32_dpp v58, v58, v58 row_ror:2 row_mask:0xf bank_mask:0xf
    v_add_f32_dpp v56, v56, v56 row_ror:1 row_mask:0xf bank_mask:0xf
    v_add_f32_dpp v190, v190, v190 row_ror:1 row_mask:0xf bank_mask:0xf
    v_add_f32_dpp v58, v58, v58 row_ror:1 row_mask:0xf bank_mask:0xf
    v_mul_f32 v56, v194, v56
    v_mul_f32 v190, v194, v190
    v_fma_f32 v190, -v56, v56, v190
    v_add_f32 v56, v50, v56
    v_cvt_pk_bf16_f32 v207, v56, v190
    v_and_b32 v190, s15, v207
    v_lshlrev_b32 v56, 16, v207
    v_add_f32 v190, 0x3727c5ac, v190
    v_sub_f32 v50, v50, v56
    v_cvt_pk_bf16_f32 v207, v190, v190
    v_fmac_f32 v58, v50, v186
    v_lshlrev_b32 v190, 16, v207
    v_sqrt_f32 v190, v190
    v_mov_b32 v57, v56
    v_cvt_pk_bf16_f32 v207, v190, v190
    s_lshl_b32 s14, s3, 2
    v_lshlrev_b32 v190, 16, v207
    v_rcp_f32 v190, v190
    v_lshrrev_b32 v209, 4, v1
    v_add_u32 v209, s14, v209
    v_fma_f32 v58, v58, v190, v187
    v_mov_b32 v191, v190
    v_cvt_pk_bf16_f32 v207, v58, v58
    v_ashrrev_i32 v208, 31, v207
    v_or_b32 v208, 0x80000000, v208
    v_xor_b32 v207, v207, v208
    v_max_u32 v207, 0x10000, v207
    s_mov_b32 exec_lo, 1
    s_mov_b32 exec_hi, 1
    ds_write_b16_d16_hi v209, v207 offset:45056
    s_mov_b64 exec, -1
    v_permlane32_swap_b32 v56, v57
    v_permlane32_swap_b32 v190, v191
    v_pk_add_f32 v[86:87], v[192:193], v[56:57] neg_lo:[0,1] neg_hi:[0,1]
    v_cvt_pk_bf16_f32 v204, v86, v87
    v_pk_add_f32 v[88:89], v[60:61], v[56:57] neg_lo:[0,1] neg_hi:[0,1]
    v_cvt_pk_bf16_f32 v205, v88, v89
    v_pk_add_f32 v[90:91], v[196:197], v[56:57] neg_lo:[0,1] neg_hi:[0,1]
    v_cvt_pk_bf16_f32 v206, v90, v91
    v_pk_add_f32 v[92:93], v[62:63], v[56:57] neg_lo:[0,1] neg_hi:[0,1]
    v_cvt_pk_bf16_f32 v207, v92, v93
    v_pk_add_f32 v[94:95], v[200:201], v[56:57] neg_lo:[0,1] neg_hi:[0,1]
    v_cvt_pk_bf16_f32 v208, v94, v95
    v_pk_add_f32 v[96:97], v[54:55], v[56:57] neg_lo:[0,1] neg_hi:[0,1]
    v_cvt_pk_bf16_f32 v209, v96, v97
    v_pk_add_f32 v[98:99], v[202:203], v[56:57] neg_lo:[0,1] neg_hi:[0,1]
    v_cvt_pk_bf16_f32 v210, v98, v99
    v_pk_add_f32 v[100:101], v[198:199], v[56:57] neg_lo:[0,1] neg_hi:[0,1]
    v_cvt_pk_bf16_f32 v211, v100, v101
    v_pk_add_f32 v[102:103], v[52:53], v[56:57] neg_lo:[0,1] neg_hi:[0,1]
    v_cvt_pk_bf16_f32 v212, v102, v103
    v_pk_add_f32 v[104:105], v[48:49], v[56:57] neg_lo:[0,1] neg_hi:[0,1]
    v_cvt_pk_bf16_f32 v213, v104, v105
    v_lshlrev_b32 v86, 16, v204
    v_and_b32 v87, s15, v204
    v_pk_mul_f32 v[86:87], v[86:87], v[190:191]
    v_cvt_pk_bf16_f32 v204, v86, v87
    v_lshlrev_b32 v88, 16, v205
    v_and_b32 v89, s15, v205
    v_pk_mul_f32 v[88:89], v[88:89], v[190:191]
    v_cvt_pk_bf16_f32 v205, v88, v89
    v_lshlrev_b32 v90, 16, v206
    v_and_b32 v91, s15, v206
    v_pk_mul_f32 v[90:91], v[90:91], v[190:191]
    v_cvt_pk_bf16_f32 v206, v90, v91
    v_lshlrev_b32 v92, 16, v207
    v_and_b32 v93, s15, v207
    v_pk_mul_f32 v[92:93], v[92:93], v[190:191]
    v_cvt_pk_bf16_f32 v207, v92, v93
    v_lshlrev_b32 v94, 16, v208
    v_and_b32 v95, s15, v208
    v_pk_mul_f32 v[94:95], v[94:95], v[190:191]
    v_cvt_pk_bf16_f32 v208, v94, v95
    v_lshlrev_b32 v96, 16, v209
    v_and_b32 v97, s15, v209
    v_pk_mul_f32 v[96:97], v[96:97], v[190:191]
    v_cvt_pk_bf16_f32 v209, v96, v97
    v_lshlrev_b32 v98, 16, v210
    v_and_b32 v99, s15, v210
    v_pk_mul_f32 v[98:99], v[98:99], v[190:191]
    v_cvt_pk_bf16_f32 v210, v98, v99
    v_lshlrev_b32 v100, 16, v211
    v_and_b32 v101, s15, v211
    v_pk_mul_f32 v[100:101], v[100:101], v[190:191]
    v_cvt_pk_bf16_f32 v211, v100, v101
    v_lshlrev_b32 v102, 16, v212
    v_and_b32 v103, s15, v212
    v_pk_mul_f32 v[102:103], v[102:103], v[190:191]
    v_cvt_pk_bf16_f32 v212, v102, v103
    v_lshlrev_b32 v104, 16, v213
    v_and_b32 v105, s15, v213
    v_pk_mul_f32 v[104:105], v[104:105], v[190:191]
    v_cvt_pk_bf16_f32 v213, v104, v105
    v_dot2_f32_bf16 v86, v204, v166, 0
    v_dot2_f32_bf16 v87, v204, v126, 0
    v_dot2_f32_bf16 v88, v205, v167, 0
    v_dot2_f32_bf16 v89, v205, v128, 0
    v_dot2_f32_bf16 v90, v206, v168, 0
    v_dot2_f32_bf16 v91, v206, v130, 0
    v_dot2_f32_bf16 v92, v207, v169, 0
    v_dot2_f32_bf16 v93, v207, v132, 0
    v_dot2_f32_bf16 v94, v208, v170, 0
    v_dot2_f32_bf16 v95, v208, v134, 0
    v_dot2_f32_bf16 v96, v209, v171, 0
    v_dot2_f32_bf16 v97, v209, v136, 0
    v_dot2_f32_bf16 v98, v210, v172, 0
    v_dot2_f32_bf16 v99, v210, v138, 0
    v_dot2_f32_bf16 v100, v211, v173, 0
    v_dot2_f32_bf16 v101, v211, v140, 0
    v_dot2_f32_bf16 v102, v212, v174, 0
    v_dot2_f32_bf16 v103, v212, v142, 0
    v_dot2_f32_bf16 v104, v213, v175, 0
    v_dot2_f32_bf16 v105, v213, v144, 0
    v_cvt_pk_bf16_f32 v204, v86, v87
    v_cvt_pk_bf16_f32 v205, v88, v89
    v_cvt_pk_bf16_f32 v206, v90, v91
    v_cvt_pk_bf16_f32 v207, v92, v93
    v_cvt_pk_bf16_f32 v208, v94, v95
    v_cvt_pk_bf16_f32 v209, v96, v97
    v_cvt_pk_bf16_f32 v210, v98, v99
    v_cvt_pk_bf16_f32 v211, v100, v101
    v_cvt_pk_bf16_f32 v212, v102, v103
    v_cvt_pk_bf16_f32 v213, v104, v105
    v_dot2_f32_bf16 v86, v204, s44, v107
    v_dot2_f32_bf16 v87, v204, s45, v107
    v_dot2_f32_bf16 v88, v205, s44, v109
    v_dot2_f32_bf16 v89, v205, s45, v109
    v_dot2_f32_bf16 v90, v206, s44, v111
    v_dot2_f32_bf16 v91, v206, s45, v111
    v_dot2_f32_bf16 v92, v207, s44, v113
    v_dot2_f32_bf16 v93, v207, s45, v113
    v_dot2_f32_bf16 v94, v208, s44, v115
    v_dot2_f32_bf16 v95, v208, s45, v115
    v_dot2_f32_bf16 v96, v209, s44, v117
    v_dot2_f32_bf16 v97, v209, s45, v117
    v_dot2_f32_bf16 v98, v210, s44, v119
    v_dot2_f32_bf16 v99, v210, s45, v119
    v_dot2_f32_bf16 v100, v211, s44, v121
    v_dot2_f32_bf16 v101, v211, s45, v121
    v_dot2_f32_bf16 v102, v212, s44, v123
    v_dot2_f32_bf16 v103, v212, s45, v123
    v_dot2_f32_bf16 v104, v213, s44, v125
    v_dot2_f32_bf16 v105, v213, s45, v125
    v_cvt_pk_bf16_f32 v204, v86, v87
    v_cvt_pk_bf16_f32 v205, v88, v89
    v_cvt_pk_bf16_f32 v206, v90, v91
    v_cvt_pk_bf16_f32 v207, v92, v93
    v_cvt_pk_bf16_f32 v208, v94, v95
    v_cvt_pk_bf16_f32 v209, v96, v97
    v_cvt_pk_bf16_f32 v210, v98, v99
    v_cvt_pk_bf16_f32 v211, v100, v101
    v_cvt_pk_bf16_f32 v212, v102, v103
    v_cvt_pk_bf16_f32 v213, v104, v105
    ds_write_b16 v66, v204 offset:24320
    ds_write_b16_d16_hi v66, v204 offset:25600
    ds_write_b16 v66, v205 offset:24448
    ds_write_b16_d16_hi v66, v205 offset:25728
    ds_write_b16 v66, v206 offset:24576
    ds_write_b16_d16_hi v66, v206 offset:25856
    ds_write_b16 v66, v207 offset:24704
    ds_write_b16_d16_hi v66, v207 offset:25984
    ds_write_b16 v66, v208 offset:24832
    ds_write_b16_d16_hi v66, v208 offset:26112
    ds_write_b16 v66, v209 offset:24960
    ds_write_b16_d16_hi v66, v209 offset:26240
    ds_write_b16 v66, v210 offset:25088
    ds_write_b16_d16_hi v66, v210 offset:26368
    ds_write_b16 v66, v211 offset:25216
    ds_write_b16_d16_hi v66, v211 offset:26496
    ds_write_b16 v66, v212 offset:25344
    ds_write_b16_d16_hi v66, v212 offset:26624
    ds_write_b16 v66, v213 offset:25472
    ds_write_b16_d16_hi v66, v213 offset:26752
    s_waitcnt lgkmcnt(0)
    s_barrier
    v_dot2_f32_bf16 v86, v204, v176, 0
    v_dot2_f32_bf16 v87, v204, v127, 0
    v_dot2_f32_bf16 v88, v205, v177, 0
    v_dot2_f32_bf16 v89, v205, v129, 0
    v_dot2_f32_bf16 v90, v206, v178, 0
    v_dot2_f32_bf16 v91, v206, v131, 0
    v_dot2_f32_bf16 v92, v207, v179, 0
    v_dot2_f32_bf16 v93, v207, v133, 0
    v_dot2_f32_bf16 v94, v208, v180, 0
    v_dot2_f32_bf16 v95, v208, v135, 0
    v_dot2_f32_bf16 v96, v209, v181, 0
    v_dot2_f32_bf16 v97, v209, v137, 0
    v_dot2_f32_bf16 v98, v210, v182, 0
    v_dot2_f32_bf16 v99, v210, v139, 0
    v_dot2_f32_bf16 v100, v211, v183, 0
    v_dot2_f32_bf16 v101, v211, v141, 0
    v_dot2_f32_bf16 v102, v212, v184, 0
    v_dot2_f32_bf16 v103, v212, v143, 0
    v_dot2_f32_bf16 v104, v213, v185, 0
    v_dot2_f32_bf16 v105, v213, v145, 0
    v_cvt_pk_bf16_f32 v204, v86, v87
    v_cvt_pk_bf16_f32 v205, v88, v89
    v_cvt_pk_bf16_f32 v206, v90, v91
    v_cvt_pk_bf16_f32 v207, v92, v93
    v_cvt_pk_bf16_f32 v208, v94, v95
    v_cvt_pk_bf16_f32 v209, v96, v97
    v_cvt_pk_bf16_f32 v210, v98, v99
    v_cvt_pk_bf16_f32 v211, v100, v101
    v_cvt_pk_bf16_f32 v212, v102, v103
    v_cvt_pk_bf16_f32 v213, v104, v105
    v_dot2_f32_bf16 v86, v204, s44, v192
    v_dot2_f32_bf16 v87, v204, s45, v193
    v_dot2_f32_bf16 v88, v205, s44, v60
    v_dot2_f32_bf16 v89, v205, s45, v61
    v_dot2_f32_bf16 v90, v206, s44, v196
    v_dot2_f32_bf16 v91, v206, s45, v197
    v_dot2_f32_bf16 v92, v207, s44, v62
    v_dot2_f32_bf16 v93, v207, s45, v63
    v_dot2_f32_bf16 v94, v208, s44, v200
    v_dot2_f32_bf16 v95, v208, s45, v201
    v_dot2_f32_bf16 v96, v209, s44, v54
    v_dot2_f32_bf16 v97, v209, s45, v55
    v_dot2_f32_bf16 v98, v210, s44, v202
    v_dot2_f32_bf16 v99, v210, s45, v203
    v_dot2_f32_bf16 v100, v211, s44, v198
    v_dot2_f32_bf16 v101, v211, s45, v199
    v_dot2_f32_bf16 v102, v212, s44, v52
    v_dot2_f32_bf16 v103, v212, s45, v53
    v_dot2_f32_bf16 v104, v213, s44, v48
    v_dot2_f32_bf16 v105, v213, s45, v49
    v_cvt_pk_bf16_f32 v204, v86, v87
    v_cvt_pk_bf16_f32 v205, v88, v89
    v_cvt_pk_bf16_f32 v206, v90, v91
    v_cvt_pk_bf16_f32 v207, v92, v93
    v_cvt_pk_bf16_f32 v208, v94, v95
    v_cvt_pk_bf16_f32 v209, v96, v97
    v_cvt_pk_bf16_f32 v210, v98, v99
    v_cvt_pk_bf16_f32 v211, v100, v101
    v_cvt_pk_bf16_f32 v212, v102, v103
    v_cvt_pk_bf16_f32 v213, v104, v105
    ds_write_b16 v66, v204 offset:34560
    ds_write_b16 v67, v106 offset:0
    ds_write_b16_d16_hi v66, v204 offset:35840
    ds_write_b16_d16_hi v67, v106 offset:1280
    ds_write_b16 v66, v205 offset:34688
    ds_write_b16 v67, v108 offset:128
    ds_write_b16_d16_hi v66, v205 offset:35968
    ds_write_b16_d16_hi v67, v108 offset:1408
    ds_write_b16 v66, v206 offset:34816
    ds_write_b16 v67, v110 offset:256
    ds_write_b16_d16_hi v66, v206 offset:36096
    ds_write_b16_d16_hi v67, v110 offset:1536
    ds_write_b16 v66, v207 offset:34944
    ds_write_b16 v67, v112 offset:384
    ds_write_b16_d16_hi v66, v207 offset:36224
    ds_write_b16_d16_hi v67, v112 offset:1664
    ds_write_b16 v66, v208 offset:35072
    ds_write_b16 v67, v114 offset:512
    ds_write_b16_d16_hi v66, v208 offset:36352
    ds_write_b16_d16_hi v67, v114 offset:1792
    ds_write_b16 v66, v209 offset:35200
    ds_write_b16 v67, v116 offset:640
    ds_write_b16_d16_hi v66, v209 offset:36480
    ds_write_b16_d16_hi v67, v116 offset:1920
    ds_write_b16 v66, v210 offset:35328
    ds_write_b16 v67, v118 offset:768
    ds_write_b16_d16_hi v66, v210 offset:36608
    ds_write_b16_d16_hi v67, v118 offset:2048
    ds_write_b16 v66, v211 offset:35456
    ds_write_b16 v67, v120 offset:896
    ds_write_b16_d16_hi v66, v211 offset:36736
    ds_write_b16_d16_hi v67, v120 offset:2176
    ds_write_b16 v66, v212 offset:35584
    ds_write_b16 v67, v122 offset:1024
    ds_write_b16_d16_hi v66, v212 offset:36864
    ds_write_b16_d16_hi v67, v122 offset:2304
    ds_write_b16 v66, v213 offset:35712
    ds_write_b16 v67, v124 offset:1152
    ds_write_b16_d16_hi v66, v213 offset:36992
    ds_write_b16_d16_hi v67, v124 offset:2432
    v_and_b32 v60, 7, v0
    v_lshrrev_b32 v61, 3, v0
    v_lshl_add_u32 v60, v60, 5, v61
    v_sub_u32 v60, 2047, v60
    v_subrev_u32 v61, 256, v60
    v_subrev_u32 v62, 512, v60
    v_subrev_u32 v63, 768, v60
    v_subrev_u32 v64, 1024, v60
    v_subrev_u32 v65, 1280, v60
    v_subrev_u32 v66, 1536, v60
    v_subrev_u32 v67, 1792, v60
    s_and_b32 s8, s2, 7
    s_lshl_b32 s8, s8, 12
    s_add_u32 s8, s8, 131072
    buffer_load_dwordx4 v[48:51], v7, s[24:27], s8 offen sc1
    s_mov_b32 vcc_lo, 0x5a5aa5a5
    s_mov_b32 vcc_hi, 0x5a5aa5a5
    v_cndmask_b32_e64 v100, 0, -1, vcc
    s_mov_b32 vcc_lo, 0x3c3cc3c3
    s_mov_b32 vcc_hi, 0x3c3cc3c3
    v_cndmask_b32_e64 v101, 0, -1, vcc
    s_mov_b32 vcc_lo, 0xf0f00f0f
    s_mov_b32 vcc_hi, 0xf0f00f0f
    v_cndmask_b32_e64 v102, 0, -1, vcc
    s_mov_b32 vcc_lo, 0xa5a5a5a5
    s_mov_b32 vcc_hi, 0x5a5a5a5a
    v_cndmask_b32_e64 v103, 0, -1, vcc
    s_mov_b32 vcc_lo, 0xc3c3c3c3
    s_mov_b32 vcc_hi, 0x3c3c3c3c
    v_cndmask_b32_e64 v104, 0, -1, vcc
    s_mov_b32 vcc_lo, 0xf0f0f0f
    s_mov_b32 vcc_hi, 0xf0f0f0f0
    v_cndmask_b32_e64 v105, 0, -1, vcc
    s_mov_b32 vcc_lo, 0xa5a5a5a5
    s_mov_b32 vcc_hi, 0xa5a5a5a5
    v_cndmask_b32_e64 v106, 0, -1, vcc
    s_mov_b32 vcc_lo, 0xc3c3c3c3
    s_mov_b32 vcc_hi, 0xc3c3c3c3
    v_cndmask_b32_e64 v107, 0, -1, vcc
    s_mov_b32 vcc_lo, 0xf0f0f0f
    s_mov_b32 vcc_hi, 0xf0f0f0f
    v_cndmask_b32_e64 v108, 0, -1, vcc
    s_bitcmp1_b32 s3, 0
    s_cselect_b32 s14, -1, 0
    v_xor_b32 v106, s14, v106
    v_xor_b32 v107, s14, v107
    v_xor_b32 v108, s14, v108
    s_mov_b32 vcc_lo, 0x55555555
    s_mov_b32 vcc_hi, 0x55555555
    v_cndmask_b32_e64 v109, 0, -1, vcc
    s_mov_b32 vcc_lo, 0x33333333
    s_mov_b32 vcc_hi, 0x33333333
    v_cndmask_b32_e64 v110, 0, -1, vcc
    s_lshl_b32 s14, s3, 5
    v_lshl_add_u32 v59, v1, 2, s14
    s_mov_b32 vcc_lo, 0x5aa55aa5
    s_mov_b32 vcc_hi, 0x5aa55aa5
    v_cndmask_b32_e64 v80, 0, -1, vcc
    s_mov_b32 vcc_lo, 0x3cc33cc3
    s_mov_b32 vcc_hi, 0x3cc33cc3
    v_cndmask_b32_e64 v81, 0, -1, vcc
    s_mov_b32 vcc_lo, 0xf00ff00f
    s_mov_b32 vcc_hi, 0xf00ff00f
    v_cndmask_b32_e64 v82, 0, -1, vcc
    v_and_b32 v77, 7, v1
    v_and_b32 v83, 8, v1
    v_lshl_add_u32 v77, v83, 1, v77
    v_lshlrev_b32 v77, 2, v77
    v_add_u32 v77, 44928, v77
    v_and_b32 v83, 48, v1
    s_movk_i32 s50, 0x7ff
    s_movk_i32 s51, 1280
    s_add_u32 s16, s84, 0xf00000
    s_addc_u32 s17, s85, 0
    s_mov_b32 s18, 0x280000
    s_mov_b32 s19, 0x00020000
    s_add_u32 s20, s84, 0xc00000
    s_addc_u32 s21, s85, 0
    s_mov_b32 s22, 0x21c000
    s_mov_b32 s23, 0x00020000
    s_mov_b32 s57, 180224
    s_cmp_ge_u32 s5, 12
    s_cselect_b32 s47, 1, 0
    s_cmp_eq_u32 s3, 0
    s_cselect_b32 s47, s47, 0
    s_lshr_b32 s46, s5, 2
    s_lshl_b32 s46, s46, 3
    s_add_u32 s46, s46, s6
    s_lshl_b32 s46, s46, 2
    s_and_b32 s14, s5, 3
    s_or_b32 s46, s46, s14
    s_cmp_lt_u32 s46, 108
    s_cbranch_scc0 Lm15
    v_bfe_u32 v111, v1, 2, 2
    v_lshrrev_b32 v112, 4, v1
    v_and_b32 v113, 3, v1
    v_lshlrev_b32 v113, 3, v113
    v_lshl_add_u32 v114, v112, 3, v111
    v_lshl_add_u32 v114, v114, 5, v113
    s_lshl_b32 s14, s3, 12
    s_add_u32 s9, s14, 69296
    v_add_u32 v114, s9, v114
    v_lshl_add_u32 v115, v112, 2, v111
    v_lshl_add_u32 v115, v115, 6, v113
    s_add_u32 s9, s14, 110256
    v_add_u32 v115, s9, v115
    s_mul_i32 s55, s46, 20480
    s_add_u32 s55, s55, s14
    v_lshlrev_b32 v116, 4, v1
    v_and_b32 v111, 7, v1
    v_lshl_add_u32 v111, v112, 3, v111
    v_lshlrev_b32 v111, 4, v111
    v_and_b32 v113, 8, v1
    v_add_u32 v118, v111, v113
    s_lshl_b32 s9, s3, 10
    v_lshl_add_u32 v117, v113, 6, v111
    v_add_u32 v117, s9, v117
    v_mov_b32 v120, 0
    v_mov_b32 v121, 0
    v_mov_b32 v122, 0
    v_mov_b32 v123, 0
    s_nop 1
Lm15:
    s_mov_b32 s7, 0
    s_branch Lp14
    s_nop 1
Lp12:
    buffer_load_dwordx4 v[48:51], v7, s[24:27], s8 offen sc1
    s_nop 1
Lp14:
    s_add_u32 s7, s7, 1
    s_waitcnt vmcnt(0)
    v_max_u32 v15, v48, v49
    v_max3_u32 v15, v15, v50, v51
    v_cmp_eq_u32 vcc, -1, v15
    s_cmp_ge_u32 s7, 20000
    s_cbranch_scc1 Lp13
    s_and_b64 exec, exec, vcc
    s_cbranch_execnz Lp12
    s_nop 1
Lp13:
    s_mov_b64 exec, -1
    v_lshl_or_b32 v60, v48, 16, v60
    v_and_or_b32 v61, v48, s15, v61
    v_lshl_or_b32 v62, v49, 16, v62
    v_and_or_b32 v63, v49, s15, v63
    v_lshl_or_b32 v64, v50, 16, v64
    v_and_or_b32 v65, v50, s15, v65
    v_lshl_or_b32 v66, v51, 16, v66
    v_and_or_b32 v67, v51, s15, v67
    v_max_u32 v76, v60, v61
    v_min_u32 v61, v60, v61
    v_max_u32 v60, v62, v63
    v_min_u32 v63, v62, v63
    v_max_u32 v62, v64, v65
    v_min_u32 v65, v64, v65
    v_max_u32 v64, v66, v67
    v_min_u32 v67, v66, v67
    v_max_u32 v66, v76, v60
    v_min_u32 v60, v76, v60
    v_max_u32 v76, v61, v63
    v_min_u32 v63, v61, v63
    v_max_u32 v61, v62, v64
    v_min_u32 v64, v62, v64
    v_max_u32 v62, v65, v67
    v_min_u32 v67, v65, v67
    v_max_u32 v65, v76, v60
    v_min_u32 v60, v76, v60
    v_max_u32 v76, v62, v64
    v_min_u32 v64, v62, v64
    v_max_u32 v62, v66, v61
    v_min_u32 v61, v66, v61
    v_max_u32 v66, v63, v67
    v_min_u32 v67, v63, v67
    v_max_u32 v63, v65, v76
    v_min_u32 v76, v65, v76
    v_max_u32 v65, v60, v64
    v_min_u32 v64, v60, v64
    v_max_u32 v60, v63, v61
    v_min_u32 v61, v63, v61
    v_max_u32 v63, v66, v64
    v_min_u32 v64, v66, v64
    v_max_u32 v66, v65, v61
    v_min_u32 v61, v65, v61
    v_max_u32 v65, v63, v76
    v_min_u32 v76, v63, v76
    v_max_u32 v63, v65, v61
    v_min_u32 v61, v65, v61
    v_max_u32_dpp v68, v67, v62 quad_perm:[1,0,3,2] row_mask:0xf bank_mask:0xf
    v_max_u32_dpp v69, v64, v60 quad_perm:[1,0,3,2] row_mask:0xf bank_mask:0xf
    v_max_u32_dpp v70, v76, v66 quad_perm:[1,0,3,2] row_mask:0xf bank_mask:0xf
    v_max_u32_dpp v71, v61, v63 quad_perm:[1,0,3,2] row_mask:0xf bank_mask:0xf
    v_mov_b32_dpp v75, v68 quad_perm:[1,0,3,2] row_mask:0xf bank_mask:0xf
    v_mov_b32_dpp v74, v69 quad_perm:[1,0,3,2] row_mask:0xf bank_mask:0xf
    v_mov_b32_dpp v73, v70 quad_perm:[1,0,3,2] row_mask:0xf bank_mask:0xf
    v_mov_b32_dpp v72, v71 quad_perm:[1,0,3,2] row_mask:0xf bank_mask:0xf
    v_med3_u32 v68, v68, v72, v109
    v_med3_u32 v70, v70, v74, v109
    v_med3_u32 v69, v69, v73, v109
    v_med3_u32 v71, v71, v75, v109
    v_max_u32 v65, v68, v70
    v_min_u32 v70, v68, v70
    v_max_u32 v68, v69, v71
    v_min_u32 v71, v69, v71
    v_max_u32 v69, v70, v71
    v_min_u32 v71, v70, v71
    v_max_u32 v70, v65, v68
    v_min_u32 v68, v65, v68
    v_max_u32_dpp v72, v71, v70 quad_perm:[3,2,1,0] row_mask:0xf bank_mask:0xf
    v_max_u32_dpp v73, v69, v68 quad_perm:[3,2,1,0] row_mask:0xf bank_mask:0xf
    s_nop 0
    v_mov_b32_dpp v74, v72 quad_perm:[1,0,3,2] row_mask:0xf bank_mask:0xf
    v_mov_b32_dpp v75, v73 quad_perm:[1,0,3,2] row_mask:0xf bank_mask:0xf
    v_med3_u32 v72, v72, v74, v109
    v_med3_u32 v73, v73, v75, v109
    s_nop 0
    v_mov_b32_dpp v75, v72 quad_perm:[2,3,0,1] row_mask:0xf bank_mask:0xf
    v_mov_b32_dpp v74, v73 quad_perm:[2,3,0,1] row_mask:0xf bank_mask:0xf
    v_med3_u32 v72, v72, v74, v110
    v_med3_u32 v73, v73, v75, v110
    v_min_u32 v60, v72, v73
    v_max_u32 v62, v72, v73
    s_nop 0
    v_max_u32_dpp v62, v60, v62 row_half_mirror row_mask:0xf bank_mask:0xf
    s_nop 1
    v_mov_b32_dpp v60, v62 quad_perm:[1,0,3,2] row_mask:0xf bank_mask:0xf
    v_med3_u32 v62, v62, v60, v80
    s_nop 1
    v_mov_b32_dpp v60, v62 quad_perm:[2,3,0,1] row_mask:0xf bank_mask:0xf
    v_med3_u32 v62, v62, v60, v81
    s_nop 1
    v_mov_b32_dpp v60, v62 row_half_mirror row_mask:0xf bank_mask:0xf
    v_med3_u32 v62, v62, v60, v82
    s_nop 1
    v_max_u32_dpp v62, v62, v62 row_ror:8 row_mask:0xf bank_mask:0xf
    s_nop 1
    v_mov_b32_dpp v60, v62 quad_perm:[1,0,3,2] row_mask:0xf bank_mask:0xf
    v_med3_u32 v62, v62, v60, v100
    s_nop 1
    v_mov_b32_dpp v60, v62 quad_perm:[2,3,0,1] row_mask:0xf bank_mask:0xf
    v_med3_u32 v62, v62, v60, v101
    s_nop 1
    v_mov_b32_dpp v60, v62 row_half_mirror row_mask:0xf bank_mask:0xf
    v_med3_u32 v62, v62, v60, v102
    v_mov_b32 v60, v62
    s_nop 1
    v_permlane16_swap_b32 v62, v60
    v_max_u32 v62, v62, v60
    s_nop 1
    v_mov_b32_dpp v60, v62 quad_perm:[1,0,3,2] row_mask:0xf bank_mask:0xf
    v_med3_u32 v62, v62, v60, v103
    s_nop 1
    v_mov_b32_dpp v60, v62 quad_perm:[2,3,0,1] row_mask:0xf bank_mask:0xf
    v_med3_u32 v62, v62, v60, v104
    s_nop 1
    v_mov_b32_dpp v60, v62 row_half_mirror row_mask:0xf bank_mask:0xf
    v_med3_u32 v62, v62, v60, v105
    v_mov_b32 v60, v62
    s_nop 1
    v_permlane32_swap_b32 v62, v60
    v_max_u32 v62, v62, v60
    s_nop 1
    v_mov_b32_dpp v60, v62 quad_perm:[1,0,3,2] row_mask:0xf bank_mask:0xf
    v_med3_u32 v62, v62, v60, v106
    s_nop 1
    v_mov_b32_dpp v60, v62 quad_perm:[2,3,0,1] row_mask:0xf bank_mask:0xf
    v_med3_u32 v62, v62, v60, v107
    s_nop 1
    v_mov_b32_dpp v60, v62 row_half_mirror row_mask:0xf bank_mask:0xf
    v_med3_u32 v62, v62, v60, v108
    s_mov_b64 exec, 0xff
    ds_write_b32 v59, v62 offset:44928
    s_mov_b64 exec, -1
    s_branch L_top
    s_nop 1
L_w4b:
    v_lshlrev_b32 v172, 4, v1
    v_lshrrev_b32 v174, 4, v1
    v_mul_u32_u24 v173, 327680, v174
    v_mul_u32_u24 v174, 1280, v174
    v_and_b32 v15, 15, v1
    v_lshlrev_b32 v15, 4, v15
    v_add_u32 v15, 1024, v15
    v_add_u32 v173, v173, v15
    v_add_u32 v174, v174, v15
    s_mul_i32 s46, s4, 1280
    s_add_u32 s47, s46, 327680
    s_add_u32 s48, s46, 655360
    s_add_u32 s49, s46, 983040
    s_add_u32 s50, s46, 1310720
    s_add_u32 s51, s46, 1638400
    s_add_u32 s52, s46, 1966080
    s_add_u32 s53, s46, 2293760
    s_add_u32 s16, s84, 0xf00000
    s_addc_u32 s17, s85, 0
    s_mov_b32 s18, 0x280000
    s_mov_b32 s19, 0x00020000
    v_lshlrev_b32 v175, 12, v1
    s_lshl_b32 s8, s2, 4
    s_add_u32 s8, s8, 131072
    v_mov_b32 v15, 0
    s_nop 1
Lw16:
    ds_read_b128 v[196:199], v15 offset:45056
    s_waitcnt lgkmcnt(0)
    v_pk_min_u16 v176, v196, v197
    v_pk_min_u16 v177, v198, v199
    v_pk_min_u16 v176, v176, v177
    v_pk_min_u16 v176, v176, v176 op_sel:[0,1] op_sel_hi:[1,0]
    v_cmp_eq_u32 vcc, 0, v176
    s_cbranch_vccnz Lw16
    v_min_u32 v196, -2, v196
    v_min_u32 v197, -2, v197
    v_min_u32 v198, -2, v198
    v_min_u32 v199, -2, v199
    s_mov_b64 exec, 0xff
    buffer_store_dwordx4 v[196:199], v175, s[24:27], s8 offen sc1
    s_mov_b64 exec, -1
    s_waitcnt lgkmcnt(0)
    s_barrier
    ds_read_b128 v[176:179], v172 offset:24320
    ds_read_b128 v[180:183], v172 offset:25600
    ds_read_b128 v[184:187], v172 offset:26880
    ds_read_b128 v[188:191], v172 offset:28160
    ds_read_b128 v[192:195], v174 offset:24320
    s_waitcnt lgkmcnt(4)
    buffer_store_dwordx4 v[176:179], v172, s[16:19], s46 offen sc1
    s_waitcnt lgkmcnt(3)
    buffer_store_dwordx4 v[180:183], v172, s[16:19], s47 offen sc1
    s_waitcnt lgkmcnt(2)
    buffer_store_dwordx4 v[184:187], v172, s[16:19], s48 offen sc1
    s_waitcnt lgkmcnt(1)
    buffer_store_dwordx4 v[188:191], v172, s[16:19], s49 offen sc1
    s_waitcnt lgkmcnt(0)
    buffer_store_dwordx4 v[192:195], v173, s[16:19], s46 offen sc1
    s_mov_b64 exec, 1
    ds_write_b32 v15, v31 offset:45088
    s_mov_b64 exec, -1
    s_mov_b32 vcc_lo, 0x5aa55aa5
    s_mov_b32 vcc_hi, 0x5aa55aa5
    v_cndmask_b32_e64 v80, 0, -1, vcc
    s_mov_b32 vcc_lo, 0x3cc33cc3
    s_mov_b32 vcc_hi, 0x3cc33cc3
    v_cndmask_b32_e64 v81, 0, -1, vcc
    s_mov_b32 vcc_lo, 0xf00ff00f
    s_mov_b32 vcc_hi, 0xf00ff00f
    v_cndmask_b32_e64 v82, 0, -1, vcc
    v_and_b32 v77, 7, v1
    v_and_b32 v83, 8, v1
    v_lshl_add_u32 v77, v83, 1, v77
    v_lshlrev_b32 v77, 2, v77
    v_add_u32 v77, 44928, v77
    v_and_b32 v83, 48, v1
    s_movk_i32 s50, 0x7ff
    s_movk_i32 s51, 1280
    s_add_u32 s16, s84, 0xf00000
    s_addc_u32 s17, s85, 0
    s_mov_b32 s18, 0x280000
    s_mov_b32 s19, 0x00020000
    s_add_u32 s20, s84, 0xc00000
    s_addc_u32 s21, s85, 0
    s_mov_b32 s22, 0x21c000
    s_mov_b32 s23, 0x00020000
    s_mov_b32 s57, 180224
    s_cmp_ge_u32 s5, 12
    s_cselect_b32 s47, 1, 0
    s_cmp_eq_u32 s3, 0
    s_cselect_b32 s47, s47, 0
    s_lshr_b32 s46, s5, 2
    s_lshl_b32 s46, s46, 3
    s_add_u32 s46, s46, s6
    s_lshl_b32 s46, s46, 2
    s_and_b32 s14, s5, 3
    s_or_b32 s46, s46, s14
    s_cmp_lt_u32 s46, 108
    s_cbranch_scc0 Lm17
    v_bfe_u32 v111, v1, 2, 2
    v_lshrrev_b32 v112, 4, v1
    v_and_b32 v113, 3, v1
    v_lshlrev_b32 v113, 3, v113
    v_lshl_add_u32 v114, v112, 3, v111
    v_lshl_add_u32 v114, v114, 5, v113
    s_lshl_b32 s14, s3, 12
    s_add_u32 s9, s14, 69296
    v_add_u32 v114, s9, v114
    v_lshl_add_u32 v115, v112, 2, v111
    v_lshl_add_u32 v115, v115, 6, v113
    s_add_u32 s9, s14, 110256
    v_add_u32 v115, s9, v115
    s_mul_i32 s55, s46, 20480
    s_add_u32 s55, s55, s14
    v_lshlrev_b32 v116, 4, v1
    v_and_b32 v111, 7, v1
    v_lshl_add_u32 v111, v112, 3, v111
    v_lshlrev_b32 v111, 4, v111
    v_and_b32 v113, 8, v1
    v_add_u32 v118, v111, v113
    s_lshl_b32 s9, s3, 10
    v_lshl_add_u32 v117, v113, 6, v111
    v_add_u32 v117, s9, v117
    v_mov_b32 v120, 0
    v_mov_b32 v121, 0
    v_mov_b32 v122, 0
    v_mov_b32 v123, 0
    s_nop 1
Lm17:
    s_nop 1
L_top:
    s_lshl_b32 s8, s3, 8
    s_waitcnt lgkmcnt(0)
    s_barrier
    ds_read2_b32 v[78:79], v77 offset0:0 offset1:8
    s_waitcnt lgkmcnt(0)
    v_max_u32 v78, v78, v79
    s_nop 1
    v_mov_b32_dpp v79, v78 quad_perm:[1,0,3,2] row_mask:0xf bank_mask:0xf
    v_med3_u32 v78, v78, v79, v80
    s_nop 1
    v_mov_b32_dpp v79, v78 quad_perm:[2,3,0,1] row_mask:0xf bank_mask:0xf
    v_med3_u32 v78, v78, v79, v81
    s_nop 1
    v_mov_b32_dpp v79, v78 row_half_mirror row_mask:0xf bank_mask:0xf
    v_med3_u32 v78, v78, v79, v82
    s_nop 1
    v_max_u32_dpp v78, v78, v78 row_ror:8 row_mask:0xf bank_mask:0xf
    s_cmp_lt_u32 s46, 108
    s_cbranch_scc0 L_nomoe
    v_bfi_b32 v180, v78, 0, s50
    v_mad_u32_u24 v180, v180, s51, v83
    s_mov_b32 exec_lo, 0x00ff00ff
    s_mov_b32 exec_hi, 0x00ff00ff
    buffer_load_dwordx4 v[84:87], v180, s[16:19], s8 offen offset:0 sc1
    buffer_load_dwordx4 v[88:91], v180, s[16:19], s8 offen offset:64 sc1
    buffer_load_dwordx4 v[92:95], v180, s[16:19], s8 offen offset:128 sc1
    buffer_load_dwordx4 v[96:99], v180, s[16:19], s8 offen offset:192 sc1
    s_mov_b64 exec, -1
    v_mov_b32 v111, 0
    s_nop 1
Lw21:
    ds_read_b32 v112, v111 offset:45092
    s_waitcnt lgkmcnt(0)
    v_readfirstlane_b32 s14, v112
    s_cmp_eq_u32 s14, 0
    s_cbranch_scc1 Lw21
    ds_read_b64_tr_b16 v[124:125], v114 offset:0
    ds_read_b64_tr_b16 v[126:127], v114 offset:128
    ds_read_b64_tr_b16 v[140:141], v114 offset:20480
    ds_read_b64_tr_b16 v[142:143], v114 offset:20608
    ds_read_b64_tr_b16 v[128:129], v114 offset:1024
    ds_read_b64_tr_b16 v[130:131], v114 offset:1152
    ds_read_b64_tr_b16 v[144:145], v114 offset:21504
    ds_read_b64_tr_b16 v[146:147], v114 offset:21632
    ds_read_b64_tr_b16 v[132:133], v114 offset:2048
    ds_read_b64_tr_b16 v[134:135], v114 offset:2176
    ds_read_b64_tr_b16 v[148:149], v114 offset:22528
    ds_read_b64_tr_b16 v[150:151], v114 offset:22656
    ds_read_b64_tr_b16 v[136:137], v114 offset:3072
    ds_read_b64_tr_b16 v[138:139], v114 offset:3200
    ds_read_b64_tr_b16 v[152:153], v114 offset:23552
    ds_read_b64_tr_b16 v[154:155], v114 offset:23680
    s_waitcnt lgkmcnt(6)
    ds_read_b64_tr_b16 v[156:157], v115 offset:0
    ds_read_b64_tr_b16 v[158:159], v115 offset:32
    ds_read_b64_tr_b16 v[160:161], v115 offset:1024
    ds_read_b64_tr_b16 v[162:163], v115 offset:1056
    ds_read_b64_tr_b16 v[164:165], v115 offset:2048
    ds_read_b64_tr_b16 v[166:167], v115 offset:2080
    ds_read_b64_tr_b16 v[168:169], v115 offset:3072
    ds_read_b64_tr_b16 v[170:171], v115 offset:3104
    s_cmp_eq_u32 s47, 0
    s_cbranch_scc1 Lh22
    s_mul_i32 s56, s6, 20
    s_add_u32 s56, s56, s5
    s_sub_u32 s56, s56, 12
    s_lshr_b32 s9, s56, 3
    s_lshl_b32 s9, s9, 5
    s_and_b32 s10, s56, 4
    s_lshl_b32 s10, s10, 2
    s_add_u32 s9, s9, s10
    s_and_b32 s10, s56, 1
    s_lshl_b32 s10, s10, 3
    s_add_u32 s9, s9, s10
    s_bitcmp1_b32 s56, 1
    s_cselect_b64 vcc, -1, 0
    s_cselect_b32 s10, 4, 0
    v_mov_b32_dpp v172, v78 row_ror:4 row_mask:0xf bank_mask:0xf
    v_cndmask_b32 v172, v78, v172, vcc
    s_nop 1
    v_mov_b32_dpp v174, v172 row_newbcast:0 row_mask:0x1 bank_mask:0xf
    v_mov_b32_dpp v174, v172 row_newbcast:1 row_mask:0x2 bank_mask:0xf
    v_mov_b32_dpp v174, v172 row_newbcast:2 row_mask:0x4 bank_mask:0xf
    v_mov_b32_dpp v174, v172 row_newbcast:3 row_mask:0x8 bank_mask:0xf
    v_and_b32 v172, 7, v1
    v_add_u32 v172, s9, v172
    v_not_b32 v179, v174
    v_and_b32 v179, 0x7ff, v179
    v_mul_u32_u24 v179, 1280, v179
    v_lshl_add_u32 v179, v172, 1, v179
    v_lshrrev_b32 v173, 4, v1
    v_add_u32 v173, s10, v173
    v_mul_u32_u24 v173, 1280, v173
    v_lshl_add_u32 v173, v172, 1, v173
    v_lshlrev_b32 v172, 2, v172
    ds_read_b32 v178, v172 offset:58032
    v_and_b32 v174, s15, v174
    v_ashrrev_i32 v172, 31, v174
    v_not_b32 v172, v172
    v_or_b32 v172, 0x80000000, v172
    v_xor_b32 v174, v174, v172
    v_and_b32 v174, s15, v174
    v_mul_f32 v174, 0xbfb8aa3b, v174
    v_exp_f32 v174, v174
    s_nop 0
    v_add_f32 v174, 1.0, v174
    v_rcp_f32 v174, v174
    s_nop 0
    v_cvt_pk_bf16_f32 v172, v174, v174
    v_lshlrev_b32 v174, 16, v172
    s_nop 1
Lh22:
    s_mov_b32 exec_lo, 0x00ff00ff
    s_mov_b32 exec_hi, 0x00ff00ff
    s_mov_b32 s7, 0
    s_branch Lp20
    s_nop 1
Lp18:
    buffer_load_dwordx4 v[84:87], v180, s[16:19], s8 offen offset:0 sc1
    buffer_load_dwordx4 v[88:91], v180, s[16:19], s8 offen offset:64 sc1
    buffer_load_dwordx4 v[92:95], v180, s[16:19], s8 offen offset:128 sc1
    buffer_load_dwordx4 v[96:99], v180, s[16:19], s8 offen offset:192 sc1
    s_nop 1
Lp20:
    s_add_u32 s7, s7, 1
    s_waitcnt vmcnt(3)
    v_max_u32 v15, v84, v85
    v_max3_u32 v15, v15, v86, v87
    s_waitcnt vmcnt(2)
    v_max3_u32 v15, v15, v88, v89
    v_max3_u32 v15, v15, v90, v91
    s_waitcnt vmcnt(1)
    v_max3_u32 v15, v15, v92, v93
    v_max3_u32 v15, v15, v94, v95
    s_waitcnt vmcnt(0)
    v_max3_u32 v15, v15, v96, v97
    v_max3_u32 v15, v15, v98, v99
    v_cmp_eq_u32 vcc, -1, v15
    s_cmp_ge_u32 s7, 20000
    s_cbranch_scc1 Lp19
    s_and_b64 exec, exec, vcc
    s_cbranch_execnz Lp18
    s_nop 1
Lp19:
    s_mov_b64 exec, -1
    s_waitcnt lgkmcnt(0)
    v_mfma_f32_16x16x32_bf16 v[188:191], v[124:127], v[84:87], 0
    v_mfma_f32_16x16x32_bf16 v[192:195], v[140:143], v[84:87], 0
    v_mfma_f32_16x16x32_bf16 v[188:191], v[128:131], v[88:91], v[188:191]
    v_mfma_f32_16x16x32_bf16 v[192:195], v[144:147], v[88:91], v[192:195]
    v_mfma_f32_16x16x32_bf16 v[188:191], v[132:135], v[92:95], v[188:191]
    v_mfma_f32_16x16x32_bf16 v[192:195], v[148:151], v[92:95], v[192:195]
    v_mfma_f32_16x16x32_bf16 v[188:191], v[136:139], v[96:99], v[188:191]
    v_mfma_f32_16x16x32_bf16 v[192:195], v[152:155], v[96:99], v[192:195]
    s_nop 7
    v_mov_b32_dpp v188, v192 row_ror:8 row_mask:0xf bank_mask:0xc
    v_mov_b32_dpp v189, v193 row_ror:8 row_mask:0xf bank_mask:0xc
    v_mov_b32_dpp v190, v194 row_ror:8 row_mask:0xf bank_mask:0xc
    v_mov_b32_dpp v191, v195 row_ror:8 row_mask:0xf bank_mask:0xc
    ds_write_b128 v117, v[188:191] offset:0
    s_waitcnt lgkmcnt(0)
    s_barrier
    ds_read2st64_b64 v[124:127], v118 offset0:0 offset1:1
    ds_read2st64_b64 v[128:131], v118 offset0:2 offset1:3
    ds_read2st64_b64 v[132:135], v118 offset0:4 offset1:5
    ds_read2st64_b64 v[136:139], v118 offset0:6 offset1:7
    ds_read2st64_b64 v[140:143], v118 offset0:8 offset1:9
    s_waitcnt lgkmcnt(3)
    v_pk_add_f32 v[124:125], v[124:125], v[128:129]
    v_pk_add_f32 v[126:127], v[126:127], v[130:131]
    s_waitcnt lgkmcnt(1)
    v_pk_add_f32 v[132:133], v[132:133], v[136:137]
    v_pk_add_f32 v[134:135], v[134:135], v[138:139]
    s_waitcnt lgkmcnt(0)
    v_pk_add_f32 v[124:125], v[124:125], v[140:141]
    v_pk_add_f32 v[126:127], v[126:127], v[142:143]
    v_pk_add_f32 v[124:125], v[124:125], v[132:133]
    v_pk_add_f32 v[126:127], v[126:127], v[134:135]
    v_cvt_pk_bf16_f32 v130, v124, v125
    v_lshlrev_b32 v124, 16, v130
    v_and_b32 v125, s15, v130
    v_mul_f32 v128, 0xbfb8aa3b, v124
    v_mul_f32 v129, 0xbfb8aa3b, v125
    v_exp_f32 v128, v128
    v_exp_f32 v129, v129
    v_cvt_pk_bf16_f32 v131, v126, v127
    v_lshlrev_b32 v126, 16, v131
    v_and_b32 v127, s15, v131
    v_add_f32 v128, 1.0, v128
    v_add_f32 v129, 1.0, v129
    v_rcp_f32 v128, v128
    v_rcp_f32 v129, v129
    s_nop 0
    v_pk_mul_f32 v[124:125], v[124:125], v[128:129]
    v_cvt_pk_bf16_f32 v130, v124, v125
    v_lshlrev_b32 v124, 16, v130
    v_and_b32 v125, s15, v130
    v_pk_mul_f32 v[124:125], v[124:125], v[126:127]
    v_cvt_pk_bf16_f32 v130, v124, v125
    s_nop 1
    v_mov_b32_dpp v120, v130 quad_perm:[0,1,2,3] row_mask:0xf bank_mask:0x3
    v_mov_b32_dpp v121, v130 row_ror:8 row_mask:0xf bank_mask:0x3
    v_mov_b32_dpp v122, v130 row_ror:8 row_mask:0xf bank_mask:0xc
    v_mov_b32_dpp v123, v130 quad_perm:[0,1,2,3] row_mask:0xf bank_mask:0xc
    s_nop 1
    v_mfma_f32_16x16x32_bf16 v[188:191], v[120:123], v[156:159], 0
    v_mfma_f32_16x16x32_bf16 v[192:195], v[120:123], v[160:163], 0
    v_mfma_f32_16x16x32_bf16 v[196:199], v[120:123], v[164:167], 0
    v_mfma_f32_16x16x32_bf16 v[200:203], v[120:123], v[168:171], 0
    s_nop 4
    v_bfi_b32 v188, v31, s66, v188
    v_bfi_b32 v189, v31, s67, v189
    v_bfi_b32 v190, v31, s82, v190
    v_bfi_b32 v191, v31, s83, v191
    buffer_store_dwordx4 v[188:191], v116, s[20:23], s55 offen offset:0 sc1
    v_bfi_b32 v192, v31, s66, v192
    v_bfi_b32 v193, v31, s67, v193
    v_bfi_b32 v194, v31, s82, v194
    v_bfi_b32 v195, v31, s83, v195
    buffer_store_dwordx4 v[192:195], v116, s[20:23], s55 offen offset:1024 sc1
    v_bfi_b32 v196, v31, s66, v196
    v_bfi_b32 v197, v31, s67, v197
    v_bfi_b32 v198, v31, s82, v198
    v_bfi_b32 v199, v31, s83, v199
    buffer_store_dwordx4 v[196:199], v116, s[20:23], s55 offen offset:2048 sc1
    v_bfi_b32 v200, v31, s66, v200
    v_bfi_b32 v201, v31, s67, v201
    v_bfi_b32 v202, v31, s82, v202
    v_bfi_b32 v203, v31, s83, v203
    buffer_store_dwordx4 v[200:203], v116, s[20:23], s55 offen offset:3072 sc1
    s_branch L_fin0
    s_nop 1
L_nomoe:
    s_cmp_eq_u32 s47, 0
    s_cbranch_scc1 Lh23
    s_mul_i32 s56, s6, 20
    s_add_u32 s56, s56, s5
    s_sub_u32 s56, s56, 12
    s_lshr_b32 s9, s56, 3
    s_lshl_b32 s9, s9, 5
    s_and_b32 s10, s56, 4
    s_lshl_b32 s10, s10, 2
    s_add_u32 s9, s9, s10
    s_and_b32 s10, s56, 1
    s_lshl_b32 s10, s10, 3
    s_add_u32 s9, s9, s10
    s_bitcmp1_b32 s56, 1
    s_cselect_b64 vcc, -1, 0
    s_cselect_b32 s10, 4, 0
    v_mov_b32_dpp v172, v78 row_ror:4 row_mask:0xf bank_mask:0xf
    v_cndmask_b32 v172, v78, v172, vcc
    s_nop 1
    v_mov_b32_dpp v174, v172 row_newbcast:0 row_mask:0x1 bank_mask:0xf
    v_mov_b32_dpp v174, v172 row_newbcast:1 row_mask:0x2 bank_mask:0xf
    v_mov_b32_dpp v174, v172 row_newbcast:2 row_mask:0x4 bank_mask:0xf
    v_mov_b32_dpp v174, v172 row_newbcast:3 row_mask:0x8 bank_mask:0xf
    v_and_b32 v172, 7, v1
    v_add_u32 v172, s9, v172
    v_not_b32 v179, v174
    v_and_b32 v179, 0x7ff, v179
    v_mul_u32_u24 v179, 1280, v179
    v_lshl_add_u32 v179, v172, 1, v179
    v_lshrrev_b32 v173, 4, v1
    v_add_u32 v173, s10, v173
    v_mul_u32_u24 v173, 1280, v173
    v_lshl_add_u32 v173, v172, 1, v173
    v_lshlrev_b32 v172, 2, v172
    ds_read_b32 v178, v172 offset:58032
    v_and_b32 v174, s15, v174
    v_ashrrev_i32 v172, 31, v174
    v_not_b32 v172, v172
    v_or_b32 v172, 0x80000000, v172
    v_xor_b32 v174, v174, v172
    v_and_b32 v174, s15, v174
    v_mul_f32 v174, 0xbfb8aa3b, v174
    v_exp_f32 v174, v174
    s_nop 0
    v_add_f32 v174, 1.0, v174
    v_rcp_f32 v174, v174
    s_nop 0
    v_cvt_pk_bf16_f32 v172, v174, v174
    v_lshlrev_b32 v174, 16, v172
    s_nop 1
Lh23:
    s_nop 1
L_fin0:
    s_cmp_lt_u32 s5, 12
    s_cbranch_scc1 L_nofin
    s_mul_i32 s46, s6, 20
    s_add_u32 s46, s46, s5
    s_sub_u32 s46, s46, 12
    s_mul_i32 s14, s3, 24
    v_lshrrev_b32 v192, 3, v1
    v_add_u32 v193, s14, v192
    v_add_u32 v195, 8, v193
    v_and_b32 v194, 7, v1
    v_lshlrev_b32 v194, 4, v194
    v_add_u32 v197, 16, v193
    v_min_u32 v197, 107, v197
    v_mul_u32_u24 v197, 20480, v197
    v_add_u32 v197, v197, v194
    v_add_u32 v196, 8, v193
    v_min_u32 v196, 107, v196
    v_mul_u32_u24 v196, 20480, v196
    v_add_u32 v196, v196, v194
    v_add_u32 v192, 0, v193
    v_min_u32 v192, 107, v192
    v_mul_u32_u24 v192, 20480, v192
    v_add_u32 v192, v192, v194
    s_lshl_b32 s8, s46, 7
    s_cmp_lg_u32 s3, 4
    s_cbranch_scc1 L_nopil
    s_mov_b64 exec, 1
    s_mov_b32 s7, 0
    s_nop 1
Lp24:
    buffer_load_dwordx4 v[180:183], v192, s[20:23], s8 offen sc1
    s_add_u32 s7, s7, 1
    s_waitcnt vmcnt(0)
    v_xor_b32 v15, s66, v180
    v_bitop3_b32 v15, v181, s67, v15 bitop3:0xbe
    v_bitop3_b32 v15, v182, s82, v15 bitop3:0xbe
    v_bitop3_b32 v15, v183, s83, v15 bitop3:0xbe
    v_and_b32 v15, v31, v15
    v_cmp_ne_u32 vcc, 0, v15
    s_cmp_ge_u32 s7, 20000
    s_cbranch_scc1 Lp25
    s_and_b64 exec, exec, vcc
    s_cbranch_execnz Lp24
    s_nop 1
Lp25:
    s_mov_b64 exec, -1
    s_nop 1
L_nopil:
    s_waitcnt lgkmcnt(0)
    s_barrier
    s_cmp_eq_u32 s47, 0
    s_cbranch_scc1 Lh27
    buffer_load_sshort v176, v179, s[16:19], 0 offen sc1
    buffer_load_sshort v177, v173, s[24:27], s57 offen sc1
    s_nop 1
Lh27:
    s_mov_b32 s7, 0
    s_nop 1
Lp28:
    buffer_load_dwordx4 v[180:183], v192, s[20:23], s8 offen sc1
    buffer_load_dwordx4 v[184:187], v196, s[20:23], s8 offen sc1
    buffer_load_dwordx4 v[188:191], v197, s[20:23], s8 offen sc1
    s_add_u32 s7, s7, 1
    s_waitcnt vmcnt(2)
    v_xor_b32 v15, s66, v180
    v_bitop3_b32 v15, v181, s67, v15 bitop3:0xbe
    v_bitop3_b32 v15, v182, s82, v15 bitop3:0xbe
    v_bitop3_b32 v15, v183, s83, v15 bitop3:0xbe
    s_waitcnt vmcnt(1)
    v_bitop3_b32 v15, v184, s66, v15 bitop3:0xbe
    v_bitop3_b32 v15, v185, s67, v15 bitop3:0xbe
    v_bitop3_b32 v15, v186, s82, v15 bitop3:0xbe
    v_bitop3_b32 v15, v187, s83, v15 bitop3:0xbe
    s_waitcnt vmcnt(0)
    v_bitop3_b32 v15, v188, s66, v15 bitop3:0xbe
    v_bitop3_b32 v15, v189, s67, v15 bitop3:0xbe
    v_bitop3_b32 v15, v190, s82, v15 bitop3:0xbe
    v_bitop3_b32 v15, v191, s83, v15 bitop3:0xbe
    v_and_b32 v15, v31, v15
    v_cmp_ne_u32 vcc, 0, v15
    s_cmp_ge_u32 s7, 20000
    s_cbranch_scc1 Lp29
    s_and_b64 exec, exec, vcc
    s_cbranch_execnz Lp28
    s_nop 1
Lp29:
    s_mov_b64 exec, -1
    v_cmp_gt_u32 vcc, 108, v195
    s_cmp_eq_u32 s3, 4
    s_cselect_b64 s[10:11], 0, -1
    s_mov_b64 exec, s[10:11]
    v_pk_add_f32 v[180:181], v[180:181], v[188:189]
    v_pk_add_f32 v[182:183], v[182:183], v[190:191]
    s_mov_b64 exec, vcc
    v_pk_add_f32 v[180:181], v[180:181], v[184:185]
    v_pk_add_f32 v[182:183], v[182:183], v[186:187]
    s_mov_b64 exec, -1
    s_nop 0
    v_permlane32_swap_b32 v180, v182
    v_permlane32_swap_b32 v181, v183
    v_pk_add_f32 v[180:181], v[180:181], v[182:183]
    s_nop 1
    v_permlane16_swap_b32 v180, v181
    v_add_f32 v180, v180, v181
    s_nop 1
    v_add_f32_dpp v180, v180, v180 row_ror:8 row_mask:0xf bank_mask:0xf
    s_lshl_b32 s14, s3, 8
    v_lshlrev_b32 v192, 2, v1
    v_add_u32 v181, s14, v192
    ds_write_b32 v181, v180 offset:8192
    s_cmp_lg_u32 s3, 0
    s_cbranch_scc1 L_fpoll
    s_mov_b32 s7, 0
    s_branch Lp33
    s_nop 1
Lp31:
    buffer_load_sshort v176, v179, s[16:19], 0 offen sc1
    buffer_load_sshort v177, v173, s[24:27], s57 offen sc1
    s_nop 1
Lp33:
    s_add_u32 s7, s7, 1
    s_waitcnt vmcnt(1)
    v_mov_b32 v15, v176
    s_waitcnt vmcnt(0)
    v_max_u32 v15, v15, v177
    v_cmp_eq_u32 vcc, -1, v15
    s_cmp_ge_u32 s7, 20000
    s_cbranch_scc1 Lp32
    s_and_b64 exec, exec, vcc
    s_cbranch_execnz Lp31
    s_nop 1
Lp32:
    s_mov_b64 exec, -1
    v_lshlrev_b32 v176, 16, v176
    v_lshlrev_b32 v177, 16, v177
    s_mov_b32 s16, s80
    s_mov_b32 s17, s81
    s_mov_b32 s18, 0x280000
    s_mov_b32 s19, 0x00020000
    s_nop 1
L_fpoll:
    s_waitcnt lgkmcnt(0)
    s_barrier
    s_cmp_lg_u32 s3, 0
    s_cbranch_scc1 L_nofin
    ds_read2st64_b32 v[184:185], v192 offset0:33 offset1:34
    ds_read2st64_b32 v[186:187], v192 offset0:35 offset1:36
    s_waitcnt lgkmcnt(0)
    v_pk_add_f32 v[184:185], v[184:185], v[186:187]
    v_add_f32 v180, v180, v184
    v_add_f32 v180, v180, v185
    v_cvt_pk_bf16_f32 v193, v180, v180
    v_lshlrev_b32 v180, 16, v193
    v_mul_f32 v180, v180, v174
    v_cvt_pk_bf16_f32 v193, v180, v180
    v_lshlrev_b32 v180, 16, v193
    v_add_f32 v180, v180, v176
    v_cvt_pk_bf16_f32 v193, v180, v180
    v_lshlrev_b32 v180, 16, v193
    v_mul_f32 v180, v180, v178
    v_cvt_pk_bf16_f32 v193, v180, v180
    v_lshlrev_b32 v180, 16, v193
    v_add_f32 v180, v180, v177
    v_cvt_pk_bf16_f32 v180, v180, v180
    s_mov_b32 exec_lo, 0x00ff00ff
    s_mov_b32 exec_hi, 0x00ff00ff
    buffer_store_short v180, v179, s[16:19], 0 offen
    s_mov_b64 exec, -1
    s_nop 1
L_nofin:
    s_endpgm
    s_nop 1
L_svc:
    s_setprio 3
    v_mul_u32_u24 v154, 3456, v1
    v_lshlrev_b32 v155, 7, v1
    v_lshlrev_b32 v136, 4, v1
    v_mov_b32 v140, -1
    v_mov_b32 v141, -1
    v_mov_b32 v142, -1
    v_mov_b32 v143, -1
    s_mul_i32 s8, s6, 10
    s_add_u32 s8, s8, s5
    s_mul_i32 s9, s6, 20
    s_add_u32 s9, s9, s5
    s_add_u32 s9, s9, 68
    s_cmp_lt_u32 s5, 10
    s_cselect_b32 s8, s8, s9
    v_lshrrev_b32 v48, 3, v1
    v_lshlrev_b32 v46, 2, v1
    v_mul_u32_u24 v47, 153600, v48
    v_and_b32 v48, 7, v1
    v_lshl_add_u32 v47, v48, 4, v47
    s_and_b32 s10, s8, 3
    s_lshr_b32 s8, s8, 2
    s_mul_i32 s9, s10, 1228800
    s_lshl_b32 s11, s8, 7
    s_add_u32 s9, s9, s11
    s_mul_i32 s11, s10, 320
    s_waitcnt lgkmcnt(0)
    s_load_dwordx2 s[58:59], s[84:85], 61440
    s_mov_b32 s24, s84
    s_mov_b32 s25, s85
    s_mov_b32 s26, 0x50000
    s_mov_b32 s27, 0x00020000
    s_cmp_ge_u32 s5, 10
    s_cbranch_scc1 L_nogemv
    s_mov_b32 s16, s76
    s_mov_b32 s17, s77
    s_mov_b32 s18, 0x500
    s_mov_b32 s19, 0x00020000
    s_mov_b32 s20, s78
    s_mov_b32 s21, s79
    s_mov_b32 s22, 0x4b0000
    s_mov_b32 s23, 0x00020000
    buffer_load_dword v42, v46, s[16:19], s11 offen
    buffer_load_dword v43, v46, s[16:19], s11 offen offset:256
    buffer_load_dwordx4 v[56:59], v47, s[20:23], s9 offen
    s_add_u32 s9, s9, 7680
    buffer_load_dwordx4 v[60:63], v47, s[20:23], s9 offen
    s_add_u32 s9, s9, 7680
    buffer_load_dwordx4 v[64:67], v47, s[20:23], s9 offen
    s_add_u32 s9, s9, 7680
    buffer_load_dwordx4 v[68:71], v47, s[20:23], s9 offen
    s_add_u32 s9, s9, 7680
    buffer_load_dwordx4 v[72:75], v47, s[20:23], s9 offen
    s_add_u32 s9, s9, 7680
    buffer_load_dwordx4 v[76:79], v47, s[20:23], s9 offen
    s_add_u32 s9, s9, 7680
    buffer_load_dwordx4 v[80:83], v47, s[20:23], s9 offen
    s_add_u32 s9, s9, 7680
    buffer_load_dwordx4 v[84:87], v47, s[20:23], s9 offen
    s_add_u32 s9, s9, 7680
    buffer_load_dwordx4 v[88:91], v47, s[20:23], s9 offen
    s_add_u32 s9, s9, 7680
    buffer_load_dwordx4 v[92:95], v47, s[20:23], s9 offen
    s_add_u32 s9, s9, 7680
    buffer_load_dwordx4 v[96:99], v47, s[20:23], s9 offen
    s_add_u32 s9, s9, 7680
    buffer_load_dwordx4 v[100:103], v47, s[20:23], s9 offen
    s_add_u32 s9, s9, 7680
    buffer_load_dwordx4 v[104:107], v47, s[20:23], s9 offen
    s_add_u32 s9, s9, 7680
    buffer_load_dwordx4 v[108:111], v47, s[20:23], s9 offen
    s_add_u32 s9, s9, 7680
    buffer_load_dwordx4 v[112:115], v47, s[20:23], s9 offen
    s_add_u32 s9, s9, 7680
    buffer_load_dwordx4 v[116:119], v47, s[20:23], s9 offen
    s_add_u32 s9, s9, 7680
    buffer_load_dwordx4 v[120:123], v47, s[20:23], s9 offen
    s_add_u32 s9, s9, 7680
    buffer_load_dwordx4 v[124:127], v47, s[20:23], s9 offen
    s_add_u32 s9, s9, 7680
    buffer_load_dwordx4 v[128:131], v47, s[20:23], s9 offen
    s_add_u32 s9, s9, 7680
    buffer_load_dwordx4 v[132:135], v47, s[20:23], s9 offen
    s_waitcnt vmcnt(21)
    v_lshlrev_b32 v44, 16, v42
    v_and_b32 v45, s15, v42
    v_mul_f32 v48, 0xbfb8aa3b, v44
    v_mul_f32 v49, 0xbfb8aa3b, v45
    v_exp_f32 v48, v48
    v_exp_f32 v49, v49
    v_add_f32 v48, 1.0, v48
    v_add_f32 v49, 1.0, v49
    v_rcp_f32 v48, v48
    v_rcp_f32 v49, v49
    s_nop 0
    v_pk_mul_f32 v[44:45], v[44:45], v[48:49]
    v_cvt_pk_bf16_f32 v42, v44, v45
    ds_write_b32 v46, v42 offset:63152
    s_waitcnt vmcnt(20)
    v_lshlrev_b32 v44, 16, v43
    v_and_b32 v45, s15, v43
    v_mul_f32 v48, 0xbfb8aa3b, v44
    v_mul_f32 v49, 0xbfb8aa3b, v45
    v_exp_f32 v48, v48
    v_exp_f32 v49, v49
    v_add_f32 v48, 1.0, v48
    v_add_f32 v49, 1.0, v49
    v_rcp_f32 v48, v48
    v_rcp_f32 v49, v49
    s_nop 0
    v_pk_mul_f32 v[44:45], v[44:45], v[48:49]
    v_cvt_pk_bf16_f32 v43, v44, v45
    ds_write_b32 v46, v43 offset:63408
    v_lshrrev_b32 v44, 3, v1
    v_mul_u32_u24 v44, 40, v44
    s_waitcnt lgkmcnt(0)
    ds_read_b64 v[32:33], v44 offset:63152
    ds_read_b64 v[34:35], v44 offset:63160
    ds_read_b64 v[36:37], v44 offset:63168
    ds_read_b64 v[38:39], v44 offset:63176
    ds_read_b64 v[40:41], v44 offset:63184
    s_mov_b32 s14, 0x05040100
    s_mov_b32 s7, 0x07060302
    v_and_b32 v46, 7, v1
    v_lshlrev_b32 v46, 5, v46
    v_lshrrev_b32 v44, 5, v1
    v_lshl_add_u32 v46, v44, 4, v46
    s_waitcnt lgkmcnt(0)
    s_waitcnt vmcnt(18)
    v_perm_b32 v44, v60, v56, s14
    v_perm_b32 v60, v60, v56, s7
    v_dot2_f32_bf16 v48, v44, v32, 0
    v_dot2_f32_bf16 v49, v60, v32, 0
    v_perm_b32 v44, v61, v57, s14
    v_perm_b32 v61, v61, v57, s7
    v_dot2_f32_bf16 v50, v44, v32, 0
    v_dot2_f32_bf16 v51, v61, v32, 0
    v_perm_b32 v44, v62, v58, s14
    v_perm_b32 v62, v62, v58, s7
    v_dot2_f32_bf16 v52, v44, v32, 0
    v_dot2_f32_bf16 v53, v62, v32, 0
    v_perm_b32 v44, v63, v59, s14
    v_perm_b32 v63, v63, v59, s7
    v_dot2_f32_bf16 v54, v44, v32, 0
    v_dot2_f32_bf16 v55, v63, v32, 0
    s_waitcnt vmcnt(16)
    v_perm_b32 v44, v68, v64, s14
    v_perm_b32 v68, v68, v64, s7
    v_dot2_f32_bf16 v48, v44, v33, v48
    v_dot2_f32_bf16 v49, v68, v33, v49
    v_perm_b32 v44, v69, v65, s14
    v_perm_b32 v69, v69, v65, s7
    v_dot2_f32_bf16 v50, v44, v33, v50
    v_dot2_f32_bf16 v51, v69, v33, v51
    v_perm_b32 v44, v70, v66, s14
    v_perm_b32 v70, v70, v66, s7
    v_dot2_f32_bf16 v52, v44, v33, v52
    v_dot2_f32_bf16 v53, v70, v33, v53
    v_perm_b32 v44, v71, v67, s14
    v_perm_b32 v71, v71, v67, s7
    v_dot2_f32_bf16 v54, v44, v33, v54
    v_dot2_f32_bf16 v55, v71, v33, v55
    s_waitcnt vmcnt(14)
    v_perm_b32 v44, v76, v72, s14
    v_perm_b32 v76, v76, v72, s7
    v_dot2_f32_bf16 v48, v44, v34, v48
    v_dot2_f32_bf16 v49, v76, v34, v49
    v_perm_b32 v44, v77, v73, s14
    v_perm_b32 v77, v77, v73, s7
    v_dot2_f32_bf16 v50, v44, v34, v50
    v_dot2_f32_bf16 v51, v77, v34, v51
    v_perm_b32 v44, v78, v74, s14
    v_perm_b32 v78, v78, v74, s7
    v_dot2_f32_bf16 v52, v44, v34, v52
    v_dot2_f32_bf16 v53, v78, v34, v53
    v_perm_b32 v44, v79, v75, s14
    v_perm_b32 v79, v79, v75, s7
    v_dot2_f32_bf16 v54, v44, v34, v54
    v_dot2_f32_bf16 v55, v79, v34, v55
    s_waitcnt vmcnt(12)
    v_perm_b32 v44, v84, v80, s14
    v_perm_b32 v84, v84, v80, s7
    v_dot2_f32_bf16 v48, v44, v35, v48
    v_dot2_f32_bf16 v49, v84, v35, v49
    v_perm_b32 v44, v85, v81, s14
    v_perm_b32 v85, v85, v81, s7
    v_dot2_f32_bf16 v50, v44, v35, v50
    v_dot2_f32_bf16 v51, v85, v35, v51
    v_perm_b32 v44, v86, v82, s14
    v_perm_b32 v86, v86, v82, s7
    v_dot2_f32_bf16 v52, v44, v35, v52
    v_dot2_f32_bf16 v53, v86, v35, v53
    v_perm_b32 v44, v87, v83, s14
    v_perm_b32 v87, v87, v83, s7
    v_dot2_f32_bf16 v54, v44, v35, v54
    v_dot2_f32_bf16 v55, v87, v35, v55
    s_waitcnt vmcnt(10)
    v_perm_b32 v44, v92, v88, s14
    v_perm_b32 v92, v92, v88, s7
    v_dot2_f32_bf16 v48, v44, v36, v48
    v_dot2_f32_bf16 v49, v92, v36, v49
    v_perm_b32 v44, v93, v89, s14
    v_perm_b32 v93, v93, v89, s7
    v_dot2_f32_bf16 v50, v44, v36, v50
    v_dot2_f32_bf16 v51, v93, v36, v51
    v_perm_b32 v44, v94, v90, s14
    v_perm_b32 v94, v94, v90, s7
    v_dot2_f32_bf16 v52, v44, v36, v52
    v_dot2_f32_bf16 v53, v94, v36, v53
    v_perm_b32 v44, v95, v91, s14
    v_perm_b32 v95, v95, v91, s7
    v_dot2_f32_bf16 v54, v44, v36, v54
    v_dot2_f32_bf16 v55, v95, v36, v55
    s_waitcnt vmcnt(8)
    v_perm_b32 v44, v100, v96, s14
    v_perm_b32 v100, v100, v96, s7
    v_dot2_f32_bf16 v48, v44, v37, v48
    v_dot2_f32_bf16 v49, v100, v37, v49
    v_perm_b32 v44, v101, v97, s14
    v_perm_b32 v101, v101, v97, s7
    v_dot2_f32_bf16 v50, v44, v37, v50
    v_dot2_f32_bf16 v51, v101, v37, v51
    v_perm_b32 v44, v102, v98, s14
    v_perm_b32 v102, v102, v98, s7
    v_dot2_f32_bf16 v52, v44, v37, v52
    v_dot2_f32_bf16 v53, v102, v37, v53
    v_perm_b32 v44, v103, v99, s14
    v_perm_b32 v103, v103, v99, s7
    v_dot2_f32_bf16 v54, v44, v37, v54
    v_dot2_f32_bf16 v55, v103, v37, v55
    s_waitcnt vmcnt(6)
    v_perm_b32 v44, v108, v104, s14
    v_perm_b32 v108, v108, v104, s7
    v_dot2_f32_bf16 v48, v44, v38, v48
    v_dot2_f32_bf16 v49, v108, v38, v49
    v_perm_b32 v44, v109, v105, s14
    v_perm_b32 v109, v109, v105, s7
    v_dot2_f32_bf16 v50, v44, v38, v50
    v_dot2_f32_bf16 v51, v109, v38, v51
    v_perm_b32 v44, v110, v106, s14
    v_perm_b32 v110, v110, v106, s7
    v_dot2_f32_bf16 v52, v44, v38, v52
    v_dot2_f32_bf16 v53, v110, v38, v53
    v_perm_b32 v44, v111, v107, s14
    v_perm_b32 v111, v111, v107, s7
    v_dot2_f32_bf16 v54, v44, v38, v54
    v_dot2_f32_bf16 v55, v111, v38, v55
    s_waitcnt vmcnt(4)
    v_perm_b32 v44, v116, v112, s14
    v_perm_b32 v116, v116, v112, s7
    v_dot2_f32_bf16 v48, v44, v39, v48
    v_dot2_f32_bf16 v49, v116, v39, v49
    v_perm_b32 v44, v117, v113, s14
    v_perm_b32 v117, v117, v113, s7
    v_dot2_f32_bf16 v50, v44, v39, v50
    v_dot2_f32_bf16 v51, v117, v39, v51
    v_perm_b32 v44, v118, v114, s14
    v_perm_b32 v118, v118, v114, s7
    v_dot2_f32_bf16 v52, v44, v39, v52
    v_dot2_f32_bf16 v53, v118, v39, v53
    v_perm_b32 v44, v119, v115, s14
    v_perm_b32 v119, v119, v115, s7
    v_dot2_f32_bf16 v54, v44, v39, v54
    v_dot2_f32_bf16 v55, v119, v39, v55
    s_waitcnt vmcnt(2)
    v_perm_b32 v44, v124, v120, s14
    v_perm_b32 v124, v124, v120, s7
    v_dot2_f32_bf16 v48, v44, v40, v48
    v_dot2_f32_bf16 v49, v124, v40, v49
    v_perm_b32 v44, v125, v121, s14
    v_perm_b32 v125, v125, v121, s7
    v_dot2_f32_bf16 v50, v44, v40, v50
    v_dot2_f32_bf16 v51, v125, v40, v51
    v_perm_b32 v44, v126, v122, s14
    v_perm_b32 v126, v126, v122, s7
    v_dot2_f32_bf16 v52, v44, v40, v52
    v_dot2_f32_bf16 v53, v126, v40, v53
    v_perm_b32 v44, v127, v123, s14
    v_perm_b32 v127, v127, v123, s7
    v_dot2_f32_bf16 v54, v44, v40, v54
    v_dot2_f32_bf16 v55, v127, v40, v55
    s_waitcnt vmcnt(0)
    v_perm_b32 v44, v132, v128, s14
    v_perm_b32 v132, v132, v128, s7
    v_dot2_f32_bf16 v48, v44, v41, v48
    v_dot2_f32_bf16 v49, v132, v41, v49
    v_perm_b32 v44, v133, v129, s14
    v_perm_b32 v133, v133, v129, s7
    v_dot2_f32_bf16 v50, v44, v41, v50
    v_dot2_f32_bf16 v51, v133, v41, v51
    v_perm_b32 v44, v134, v130, s14
    v_perm_b32 v134, v134, v130, s7
    v_dot2_f32_bf16 v52, v44, v41, v52
    v_dot2_f32_bf16 v53, v134, v41, v53
    v_perm_b32 v44, v135, v131, s14
    v_perm_b32 v135, v135, v131, s7
    v_dot2_f32_bf16 v54, v44, v41, v54
    v_dot2_f32_bf16 v55, v135, v41, v55
    v_permlane32_swap_b32 v48, v52
    v_permlane32_swap_b32 v49, v53
    v_permlane32_swap_b32 v50, v54
    v_permlane32_swap_b32 v51, v55
    v_add_f32 v48, v48, v52
    v_add_f32 v49, v49, v53
    v_add_f32 v50, v50, v54
    v_add_f32 v51, v51, v55
    s_nop 0
    v_permlane16_swap_b32 v48, v50
    v_permlane16_swap_b32 v49, v51
    v_add_f32 v48, v48, v50
    v_add_f32 v49, v49, v51
    s_nop 0
    v_add_f32_dpp v48, v48, v48 row_ror:8 row_mask:0xf bank_mask:0xf
    v_add_f32_dpp v49, v49, v49 row_ror:8 row_mask:0xf bank_mask:0xf
    v_mov_b32 v50, v48
    v_mov_b32 v51, v49
    s_nop 0
    v_permlane16_swap_b32 v48, v50
    v_permlane16_swap_b32 v49, v51
    s_waitcnt lgkmcnt(0)
    s_add_u32 s58, s58, 1
    s_addc_u32 s59, s59, 0
    s_lshr_b64 s[82:83], s[58:59], 30
    s_xor_b32 s83, s82, 0x2b7
    s_and_b32 s83, s83, 0x3ff
    s_and_b32 s66, s58, 0x3ff
    s_bfe_u32 s67, s58, 0xa000a
    s_bfe_u32 s82, s58, 0xa0014
    s_xor_b32 s67, s67, 0x1d3
    s_xor_b32 s82, s82, 0x36c
    s_mul_i32 s9, s10, 15360
    s_lshl_b32 s11, s8, 8
    s_add_u32 s9, s9, s11
    v_bfi_b32 v48, v31, s66, v48
    v_bfi_b32 v49, v31, s67, v49
    v_bfi_b32 v50, v31, s82, v50
    v_bfi_b32 v51, v31, s83, v51
    s_mov_b32 exec_lo, 0xff
    s_mov_b32 exec_hi, 0xff
    buffer_store_dwordx4 v[48:51], v46, s[24:27], s9 offen sc1
    s_mov_b64 exec, -1
    s_branch L_sb1
    s_nop 1
L_nogemv:
    s_waitcnt lgkmcnt(0)
    s_add_u32 s58, s58, 1
    s_addc_u32 s59, s59, 0
    s_lshr_b64 s[82:83], s[58:59], 30
    s_xor_b32 s83, s82, 0x2b7
    s_and_b32 s83, s83, 0x3ff
    s_and_b32 s66, s58, 0x3ff
    s_bfe_u32 s67, s58, 0xa000a
    s_bfe_u32 s82, s58, 0xa0014
    s_xor_b32 s67, s67, 0x1d3
    s_xor_b32 s82, s82, 0x36c
    s_nop 1
L_sb1:
    s_barrier
    s_nop 1
L_sb2:
    s_lshr_b32 s30, s5, 2
    s_lshl_b32 s30, s30, 3
    s_add_u32 s30, s30, s6
    s_lshl_b32 s30, s30, 2
    s_and_b32 s14, s5, 3
    s_or_b32 s30, s30, s14
    s_cmp_lt_u32 s30, 108
    s_cselect_b32 s31, 2211840, 0
    s_mov_b32 s36, s70
    s_mov_b32 s37, s71
    s_mov_b32 s38, s31
    s_mov_b32 s39, 0x00020000
    s_mov_b32 s40, s72
    s_mov_b32 s41, s73
    s_mov_b32 s42, s31
    s_mov_b32 s43, 0x00020000
    s_mov_b32 s44, s74
    s_mov_b32 s45, s75
    s_mov_b32 s46, s31
    s_mov_b32 s47, 0x00020000
    v_lshrrev_b32 v152, 1, v1
    v_mul_u32_u24 v152, 3456, v152
    v_and_b32 v153, 1, v1
    v_lshl_add_u32 v152, v153, 4, v152
    v_lshrrev_b32 v153, 2, v1
    v_mul_u32_u24 v153, 1280, v153
    v_and_b32 v15, 3, v1
    v_lshl_add_u32 v153, v15, 4, v153
    v_add_u32 v144, 256, v1
    v_lshlrev_b32 v176, 4, v144
    v_cmp_lt_u32 vcc, 159, v144
    s_nop 1
    v_cndmask_b32_e64 v177, 0, 1.0, vcc
    s_mov_b32 s16, 15360
    s_mov_b32 s17, 30720
    s_mov_b32 s18, 46080
    s_waitcnt lgkmcnt(0)
    s_barrier
    s_mov_b32 s7, 0
    s_nop 1
Lp34:
    buffer_load_dwordx4 v[160:163], v176, s[24:27], 0 offen sc1
    buffer_load_dwordx4 v[164:167], v176, s[24:27], s16 offen sc1
    buffer_load_dwordx4 v[168:171], v176, s[24:27], s17 offen sc1
    buffer_load_dwordx4 v[172:175], v176, s[24:27], s18 offen sc1
    s_add_u32 s7, s7, 1
    s_waitcnt vmcnt(3)
    v_xor_b32 v15, s66, v160
    v_bitop3_b32 v15, v161, s67, v15 bitop3:0xbe
    v_bitop3_b32 v15, v162, s82, v15 bitop3:0xbe
    v_bitop3_b32 v15, v163, s83, v15 bitop3:0xbe
    s_waitcnt vmcnt(2)
    v_bitop3_b32 v15, v164, s66, v15 bitop3:0xbe
    v_bitop3_b32 v15, v165, s67, v15 bitop3:0xbe
    v_bitop3_b32 v15, v166, s82, v15 bitop3:0xbe
    v_bitop3_b32 v15, v167, s83, v15 bitop3:0xbe
    s_waitcnt vmcnt(1)
    v_bitop3_b32 v15, v168, s66, v15 bitop3:0xbe
    v_bitop3_b32 v15, v169, s67, v15 bitop3:0xbe
    v_bitop3_b32 v15, v170, s82, v15 bitop3:0xbe
    v_bitop3_b32 v15, v171, s83, v15 bitop3:0xbe
    s_waitcnt vmcnt(0)
    v_bitop3_b32 v15, v172, s66, v15 bitop3:0xbe
    v_bitop3_b32 v15, v173, s67, v15 bitop3:0xbe
    v_bitop3_b32 v15, v174, s82, v15 bitop3:0xbe
    v_bitop3_b32 v15, v175, s83, v15 bitop3:0xbe
    v_and_b32 v15, v31, v15
    v_cmp_ne_u32 vcc, 0, v15
    s_cmp_ge_u32 s7, 20000
    s_cbranch_scc1 Lp35
    s_and_b64 exec, exec, vcc
    s_cbranch_execnz Lp34
    s_nop 1
Lp35:
    s_mov_b64 exec, -1
    v_pk_add_f32 v[160:161], v[160:161], v[164:165]
    v_pk_add_f32 v[168:169], v[168:169], v[172:173]
    v_pk_add_f32 v[160:161], v[160:161], v[168:169]
    v_pk_add_f32 v[162:163], v[162:163], v[166:167]
    v_pk_add_f32 v[170:171], v[170:171], v[174:175]
    v_pk_add_f32 v[162:163], v[162:163], v[170:171]
    v_cvt_pk_bf16_f32 v164, v160, v161
    v_lshlrev_b32 v160, 16, v164
    v_and_b32 v161, s15, v164
    v_cvt_pk_bf16_f32 v166, v162, v163
    v_lshlrev_b32 v162, 16, v166
    v_and_b32 v163, s15, v166
    v_add_f32 v160, v177, v160
    v_add_f32 v161, v177, v161
    v_add_f32 v162, v177, v162
    v_add_f32 v163, v177, v163
    v_cvt_pk_bf16_f32 v164, v160, v161
    v_lshlrev_b32 v160, 16, v164
    v_and_b32 v161, s15, v164
    v_cvt_pk_bf16_f32 v166, v162, v163
    v_lshlrev_b32 v162, 16, v166
    v_and_b32 v163, s15, v166
    ds_write_b128 v176, v[160:163] offset:45232
    s_setprio 0
    s_waitcnt lgkmcnt(0)
    s_barrier
    s_cmp_lt_u32 s5, 12
    s_cbranch_scc1 L_nor1
    s_mov_b32 s16, s76
    s_mov_b32 s17, s77
    s_mov_b32 s18, 0x500
    s_mov_b32 s19, 0x00020000
    s_mov_b32 s20, s78
    s_mov_b32 s21, s79
    s_mov_b32 s22, 0x4b0000
    s_mov_b32 s23, 0x00020000
    buffer_load_dword v42, v46, s[16:19], s11 offen
    buffer_load_dword v43, v46, s[16:19], s11 offen offset:256
    buffer_load_dwordx4 v[56:59], v47, s[20:23], s9 offen
    s_add_u32 s9, s9, 7680
    buffer_load_dwordx4 v[60:63], v47, s[20:23], s9 offen
    s_add_u32 s9, s9, 7680
    buffer_load_dwordx4 v[64:67], v47, s[20:23], s9 offen
    s_add_u32 s9, s9, 7680
    buffer_load_dwordx4 v[68:71], v47, s[20:23], s9 offen
    s_add_u32 s9, s9, 7680
    buffer_load_dwordx4 v[72:75], v47, s[20:23], s9 offen
    s_add_u32 s9, s9, 7680
    buffer_load_dwordx4 v[76:79], v47, s[20:23], s9 offen
    s_add_u32 s9, s9, 7680
    buffer_load_dwordx4 v[80:83], v47, s[20:23], s9 offen
    s_add_u32 s9, s9, 7680
    buffer_load_dwordx4 v[84:87], v47, s[20:23], s9 offen
    s_add_u32 s9, s9, 7680
    buffer_load_dwordx4 v[88:91], v47, s[20:23], s9 offen
    s_add_u32 s9, s9, 7680
    buffer_load_dwordx4 v[92:95], v47, s[20:23], s9 offen
    s_add_u32 s9, s9, 7680
    buffer_load_dwordx4 v[96:99], v47, s[20:23], s9 offen
    s_add_u32 s9, s9, 7680
    buffer_load_dwordx4 v[100:103], v47, s[20:23], s9 offen
    s_add_u32 s9, s9, 7680
    buffer_load_dwordx4 v[104:107], v47, s[20:23], s9 offen
    s_add_u32 s9, s9, 7680
    buffer_load_dwordx4 v[108:111], v47, s[20:23], s9 offen
    s_add_u32 s9, s9, 7680
    buffer_load_dwordx4 v[112:115], v47, s[20:23], s9 offen
    s_add_u32 s9, s9, 7680
    buffer_load_dwordx4 v[116:119], v47, s[20:23], s9 offen
    s_add_u32 s9, s9, 7680
    buffer_load_dwordx4 v[120:123], v47, s[20:23], s9 offen
    s_add_u32 s9, s9, 7680
    buffer_load_dwordx4 v[124:127], v47, s[20:23], s9 offen
    s_add_u32 s9, s9, 7680
    buffer_load_dwordx4 v[128:131], v47, s[20:23], s9 offen
    s_add_u32 s9, s9, 7680
    buffer_load_dwordx4 v[132:135], v47, s[20:23], s9 offen
    s_waitcnt lgkmcnt(0)
    s_barrier
    s_waitcnt lgkmcnt(0)
    s_barrier
    s_waitcnt vmcnt(21)
    v_lshlrev_b32 v44, 16, v42
    v_and_b32 v45, s15, v42
    v_mul_f32 v48, 0xbfb8aa3b, v44
    v_mul_f32 v49, 0xbfb8aa3b, v45
    v_exp_f32 v48, v48
    v_exp_f32 v49, v49
    v_add_f32 v48, 1.0, v48
    v_add_f32 v49, 1.0, v49
    v_rcp_f32 v48, v48
    v_rcp_f32 v49, v49
    s_nop 0
    v_pk_mul_f32 v[44:45], v[44:45], v[48:49]
    v_cvt_pk_bf16_f32 v42, v44, v45
    ds_write_b32 v46, v42 offset:63152
    s_waitcnt vmcnt(20)
    v_lshlrev_b32 v44, 16, v43
    v_and_b32 v45, s15, v43
    v_mul_f32 v48, 0xbfb8aa3b, v44
    v_mul_f32 v49, 0xbfb8aa3b, v45
    v_exp_f32 v48, v48
    v_exp_f32 v49, v49
    v_add_f32 v48, 1.0, v48
    v_add_f32 v49, 1.0, v49
    v_rcp_f32 v48, v48
    v_rcp_f32 v49, v49
    s_nop 0
    v_pk_mul_f32 v[44:45], v[44:45], v[48:49]
    v_cvt_pk_bf16_f32 v43, v44, v45
    ds_write_b32 v46, v43 offset:63408
    v_lshrrev_b32 v44, 3, v1
    v_mul_u32_u24 v44, 40, v44
    s_waitcnt lgkmcnt(0)
    ds_read_b64 v[32:33], v44 offset:63152
    ds_read_b64 v[34:35], v44 offset:63160
    ds_read_b64 v[36:37], v44 offset:63168
    ds_read_b64 v[38:39], v44 offset:63176
    ds_read_b64 v[40:41], v44 offset:63184
    s_mov_b32 s14, 0x05040100
    s_mov_b32 s7, 0x07060302
    v_and_b32 v46, 7, v1
    v_lshlrev_b32 v46, 5, v46
    v_lshrrev_b32 v44, 5, v1
    v_lshl_add_u32 v46, v44, 4, v46
    s_waitcnt lgkmcnt(0)
    s_waitcnt vmcnt(18)
    v_perm_b32 v44, v60, v56, s14
    v_perm_b32 v60, v60, v56, s7
    v_dot2_f32_bf16 v48, v44, v32, 0
    v_dot2_f32_bf16 v49, v60, v32, 0
    v_perm_b32 v44, v61, v57, s14
    v_perm_b32 v61, v61, v57, s7
    v_dot2_f32_bf16 v50, v44, v32, 0
    v_dot2_f32_bf16 v51, v61, v32, 0
    v_perm_b32 v44, v62, v58, s14
    v_perm_b32 v62, v62, v58, s7
    v_dot2_f32_bf16 v52, v44, v32, 0
    v_dot2_f32_bf16 v53, v62, v32, 0
    v_perm_b32 v44, v63, v59, s14
    v_perm_b32 v63, v63, v59, s7
    v_dot2_f32_bf16 v54, v44, v32, 0
    v_dot2_f32_bf16 v55, v63, v32, 0
    s_waitcnt vmcnt(16)
    v_perm_b32 v44, v68, v64, s14
    v_perm_b32 v68, v68, v64, s7
    v_dot2_f32_bf16 v48, v44, v33, v48
    v_dot2_f32_bf16 v49, v68, v33, v49
    v_perm_b32 v44, v69, v65, s14
    v_perm_b32 v69, v69, v65, s7
    v_dot2_f32_bf16 v50, v44, v33, v50
    v_dot2_f32_bf16 v51, v69, v33, v51
    v_perm_b32 v44, v70, v66, s14
    v_perm_b32 v70, v70, v66, s7
    v_dot2_f32_bf16 v52, v44, v33, v52
    v_dot2_f32_bf16 v53, v70, v33, v53
    v_perm_b32 v44, v71, v67, s14
    v_perm_b32 v71, v71, v67, s7
    v_dot2_f32_bf16 v54, v44, v33, v54
    v_dot2_f32_bf16 v55, v71, v33, v55
    s_waitcnt vmcnt(14)
    v_perm_b32 v44, v76, v72, s14
    v_perm_b32 v76, v76, v72, s7
    v_dot2_f32_bf16 v48, v44, v34, v48
    v_dot2_f32_bf16 v49, v76, v34, v49
    v_perm_b32 v44, v77, v73, s14
    v_perm_b32 v77, v77, v73, s7
    v_dot2_f32_bf16 v50, v44, v34, v50
    v_dot2_f32_bf16 v51, v77, v34, v51
    v_perm_b32 v44, v78, v74, s14
    v_perm_b32 v78, v78, v74, s7
    v_dot2_f32_bf16 v52, v44, v34, v52
    v_dot2_f32_bf16 v53, v78, v34, v53
    v_perm_b32 v44, v79, v75, s14
    v_perm_b32 v79, v79, v75, s7
    v_dot2_f32_bf16 v54, v44, v34, v54
    v_dot2_f32_bf16 v55, v79, v34, v55
    s_waitcnt vmcnt(12)
    v_perm_b32 v44, v84, v80, s14
    v_perm_b32 v84, v84, v80, s7
    v_dot2_f32_bf16 v48, v44, v35, v48
    v_dot2_f32_bf16 v49, v84, v35, v49
    v_perm_b32 v44, v85, v81, s14
    v_perm_b32 v85, v85, v81, s7
    v_dot2_f32_bf16 v50, v44, v35, v50
    v_dot2_f32_bf16 v51, v85, v35, v51
    v_perm_b32 v44, v86, v82, s14
    v_perm_b32 v86, v86, v82, s7
    v_dot2_f32_bf16 v52, v44, v35, v52
    v_dot2_f32_bf16 v53, v86, v35, v53
    v_perm_b32 v44, v87, v83, s14
    v_perm_b32 v87, v87, v83, s7
    v_dot2_f32_bf16 v54, v44, v35, v54
    v_dot2_f32_bf16 v55, v87, v35, v55
    s_waitcnt vmcnt(10)
    v_perm_b32 v44, v92, v88, s14
    v_perm_b32 v92, v92, v88, s7
    v_dot2_f32_bf16 v48, v44, v36, v48
    v_dot2_f32_bf16 v49, v92, v36, v49
    v_perm_b32 v44, v93, v89, s14
    v_perm_b32 v93, v93, v89, s7
    v_dot2_f32_bf16 v50, v44, v36, v50
    v_dot2_f32_bf16 v51, v93, v36, v51
    v_perm_b32 v44, v94, v90, s14
    v_perm_b32 v94, v94, v90, s7
    v_dot2_f32_bf16 v52, v44, v36, v52
    v_dot2_f32_bf16 v53, v94, v36, v53
    v_perm_b32 v44, v95, v91, s14
    v_perm_b32 v95, v95, v91, s7
    v_dot2_f32_bf16 v54, v44, v36, v54
    v_dot2_f32_bf16 v55, v95, v36, v55
    s_waitcnt vmcnt(8)
    v_perm_b32 v44, v100, v96, s14
    v_perm_b32 v100, v100, v96, s7
    v_dot2_f32_bf16 v48, v44, v37, v48
    v_dot2_f32_bf16 v49, v100, v37, v49
    v_perm_b32 v44, v101, v97, s14
    v_perm_b32 v101, v101, v97, s7
    v_dot2_f32_bf16 v50, v44, v37, v50
    v_dot2_f32_bf16 v51, v101, v37, v51
    v_perm_b32 v44, v102, v98, s14
    v_perm_b32 v102, v102, v98, s7
    v_dot2_f32_bf16 v52, v44, v37, v52
    v_dot2_f32_bf16 v53, v102, v37, v53
    v_perm_b32 v44, v103, v99, s14
    v_perm_b32 v103, v103, v99, s7
    v_dot2_f32_bf16 v54, v44, v37, v54
    v_dot2_f32_bf16 v55, v103, v37, v55
    s_waitcnt vmcnt(6)
    v_perm_b32 v44, v108, v104, s14
    v_perm_b32 v108, v108, v104, s7
    v_dot2_f32_bf16 v48, v44, v38, v48
    v_dot2_f32_bf16 v49, v108, v38, v49
    v_perm_b32 v44, v109, v105, s14
    v_perm_b32 v109, v109, v105, s7
    v_dot2_f32_bf16 v50, v44, v38, v50
    v_dot2_f32_bf16 v51, v109, v38, v51
    v_perm_b32 v44, v110, v106, s14
    v_perm_b32 v110, v110, v106, s7
    v_dot2_f32_bf16 v52, v44, v38, v52
    v_dot2_f32_bf16 v53, v110, v38, v53
    v_perm_b32 v44, v111, v107, s14
    v_perm_b32 v111, v111, v107, s7
    v_dot2_f32_bf16 v54, v44, v38, v54
    v_dot2_f32_bf16 v55, v111, v38, v55
    s_waitcnt vmcnt(4)
    v_perm_b32 v44, v116, v112, s14
    v_perm_b32 v116, v116, v112, s7
    v_dot2_f32_bf16 v48, v44, v39, v48
    v_dot2_f32_bf16 v49, v116, v39, v49
    v_perm_b32 v44, v117, v113, s14
    v_perm_b32 v117, v117, v113, s7
    v_dot2_f32_bf16 v50, v44, v39, v50
    v_dot2_f32_bf16 v51, v117, v39, v51
    v_perm_b32 v44, v118, v114, s14
    v_perm_b32 v118, v118, v114, s7
    v_dot2_f32_bf16 v52, v44, v39, v52
    v_dot2_f32_bf16 v53, v118, v39, v53
    v_perm_b32 v44, v119, v115, s14
    v_perm_b32 v119, v119, v115, s7
    v_dot2_f32_bf16 v54, v44, v39, v54
    v_dot2_f32_bf16 v55, v119, v39, v55
    s_waitcnt vmcnt(2)
    v_perm_b32 v44, v124, v120, s14
    v_perm_b32 v124, v124, v120, s7
    v_dot2_f32_bf16 v48, v44, v40, v48
    v_dot2_f32_bf16 v49, v124, v40, v49
    v_perm_b32 v44, v125, v121, s14
    v_perm_b32 v125, v125, v121, s7
    v_dot2_f32_bf16 v50, v44, v40, v50
    v_dot2_f32_bf16 v51, v125, v40, v51
    v_perm_b32 v44, v126, v122, s14
    v_perm_b32 v126, v126, v122, s7
    v_dot2_f32_bf16 v52, v44, v40, v52
    v_dot2_f32_bf16 v53, v126, v40, v53
    v_perm_b32 v44, v127, v123, s14
    v_perm_b32 v127, v127, v123, s7
    v_dot2_f32_bf16 v54, v44, v40, v54
    v_dot2_f32_bf16 v55, v127, v40, v55
    s_waitcnt vmcnt(0)
    v_perm_b32 v44, v132, v128, s14
    v_perm_b32 v132, v132, v128, s7
    v_dot2_f32_bf16 v48, v44, v41, v48
    v_dot2_f32_bf16 v49, v132, v41, v49
    v_perm_b32 v44, v133, v129, s14
    v_perm_b32 v133, v133, v129, s7
    v_dot2_f32_bf16 v50, v44, v41, v50
    v_dot2_f32_bf16 v51, v133, v41, v51
    v_perm_b32 v44, v134, v130, s14
    v_perm_b32 v134, v134, v130, s7
    v_dot2_f32_bf16 v52, v44, v41, v52
    v_dot2_f32_bf16 v53, v134, v41, v53
    v_perm_b32 v44, v135, v131, s14
    v_perm_b32 v135, v135, v131, s7
    v_dot2_f32_bf16 v54, v44, v41, v54
    v_dot2_f32_bf16 v55, v135, v41, v55
    v_permlane32_swap_b32 v48, v52
    v_permlane32_swap_b32 v49, v53
    v_permlane32_swap_b32 v50, v54
    v_permlane32_swap_b32 v51, v55
    v_add_f32 v48, v48, v52
    v_add_f32 v49, v49, v53
    v_add_f32 v50, v50, v54
    v_add_f32 v51, v51, v55
    s_nop 0
    v_permlane16_swap_b32 v48, v50
    v_permlane16_swap_b32 v49, v51
    v_add_f32 v48, v48, v50
    v_add_f32 v49, v49, v51
    s_nop 0
    v_add_f32_dpp v48, v48, v48 row_ror:8 row_mask:0xf bank_mask:0xf
    v_add_f32_dpp v49, v49, v49 row_ror:8 row_mask:0xf bank_mask:0xf
    v_mov_b32 v50, v48
    v_mov_b32 v51, v49
    s_nop 0
    v_permlane16_swap_b32 v48, v50
    v_permlane16_swap_b32 v49, v51
    s_cmp_eq_u32 s10, 0
    s_cbranch_scc1 L_red
    s_mul_i32 s9, s10, 15360
    s_lshl_b32 s11, s8, 8
    s_add_u32 s9, s9, s11
    v_bfi_b32 v48, v31, s66, v48
    v_bfi_b32 v49, v31, s67, v49
    v_bfi_b32 v50, v31, s82, v50
    v_bfi_b32 v51, v31, s83, v51
    s_mov_b32 exec_lo, 0xff
    s_mov_b32 exec_hi, 0xff
    buffer_store_dwordx4 v[48:51], v46, s[24:27], s9 offen sc1
    s_mov_b64 exec, -1
    s_branch L_nosp
    s_nop 1
L_red:
    s_lshl_b32 s11, s8, 8
    s_add_u32 s16, s11, 15360
    s_add_u32 s17, s11, 30720
    s_add_u32 s18, s11, 46080
    s_waitcnt lgkmcnt(0)
    s_barrier
    s_mov_b32 s7, 0
    s_nop 1
Lp37:
    buffer_load_dwordx4 v[56:59], v46, s[24:27], s16 offen sc1
    buffer_load_dwordx4 v[60:63], v46, s[24:27], s17 offen sc1
    buffer_load_dwordx4 v[64:67], v46, s[24:27], s18 offen sc1
    s_add_u32 s7, s7, 1
    s_waitcnt vmcnt(2)
    v_xor_b32 v15, s66, v56
    v_bitop3_b32 v15, v57, s67, v15 bitop3:0xbe
    v_bitop3_b32 v15, v58, s82, v15 bitop3:0xbe
    v_bitop3_b32 v15, v59, s83, v15 bitop3:0xbe
    s_waitcnt vmcnt(1)
    v_bitop3_b32 v15, v60, s66, v15 bitop3:0xbe
    v_bitop3_b32 v15, v61, s67, v15 bitop3:0xbe
    v_bitop3_b32 v15, v62, s82, v15 bitop3:0xbe
    v_bitop3_b32 v15, v63, s83, v15 bitop3:0xbe
    s_waitcnt vmcnt(0)
    v_bitop3_b32 v15, v64, s66, v15 bitop3:0xbe
    v_bitop3_b32 v15, v65, s67, v15 bitop3:0xbe
    v_bitop3_b32 v15, v66, s82, v15 bitop3:0xbe
    v_bitop3_b32 v15, v67, s83, v15 bitop3:0xbe
    v_and_b32 v15, v31, v15
    v_cmp_ne_u32 vcc, 0, v15
    s_cmp_ge_u32 s7, 20000
    s_cbranch_scc1 Lp38
    s_and_b64 exec, exec, vcc
    s_cbranch_execnz Lp37
    s_nop 1
Lp38:
    s_mov_b64 exec, -1
    v_pk_add_f32 v[48:49], v[48:49], v[56:57]
    v_pk_add_f32 v[60:61], v[60:61], v[64:65]
    v_pk_add_f32 v[48:49], v[48:49], v[60:61]
    v_cvt_pk_bf16_f32 v15, v48, v49
    v_lshlrev_b32 v48, 16, v15
    v_and_b32 v49, s15, v15
    v_pk_add_f32 v[50:51], v[50:51], v[58:59]
    v_pk_add_f32 v[62:63], v[62:63], v[66:67]
    v_pk_add_f32 v[50:51], v[50:51], v[62:63]
    v_cvt_pk_bf16_f32 v15, v50, v51
    v_lshlrev_b32 v50, 16, v15
    v_and_b32 v51, s15, v15
    s_sub_u32 s9, s8, 40
    s_cmp_lt_u32 s9, 10
    s_cselect_b32 s9, 1.0, 0
    v_add_f32 v48, s9, v48
    v_add_f32 v49, s9, v49
    v_add_f32 v50, s9, v50
    v_add_f32 v51, s9, v51
    v_cvt_pk_bf16_f32 v51, v50, v51
    v_cvt_pk_bf16_f32 v50, v48, v49
    v_mov_b32 v48, s58
    v_mov_b32 v49, s59
    s_sub_u32 s9, s8, 20
    s_lshl_b32 s9, s9, 8
    s_add_u32 s9, s9, 163840
    s_mov_b32 exec_lo, 0xff
    s_mov_b32 exec_hi, 0xff
    buffer_store_dwordx4 v[48:51], v46, s[24:27], s9 offen sc1
    s_mov_b64 exec, -1
    s_branch L_sb5
    s_nop 1
L_nor1:
    s_waitcnt lgkmcnt(0)
    s_barrier
    s_waitcnt lgkmcnt(0)
    s_barrier
    s_cmp_lg_u32 s5, 0
    s_cbranch_scc1 L_nosp
    s_sub_u32 s9, 8, s6
    s_add_u32 s10, s6, 8
    s_sub_u32 s11, 16, s6
    s_cmp_gt_u32 s6, 4
    s_cselect_b32 s8, s11, s6
    s_cselect_b32 s9, s10, s9
    s_and_b32 s11, s6, 3
    s_cmp_eq_u32 s11, 0
    s_cselect_b32 s9, s10, s9
    s_mov_b32 s28, 0x334ccccd
    s_cselect_b32 s29, s28, 0
    s_lshl_b32 s8, s8, 11
    s_add_u32 s8, s8, 65536
    s_lshl_b32 s9, s9, 11
    s_add_u32 s9, s9, 65536
    s_mov_b32 s7, 0
    s_nop 1
Lp40:
    buffer_load_dwordx4 v[56:59], v136, s[24:27], s8 offen offset:0 sc1
    buffer_load_dwordx4 v[60:63], v136, s[24:27], s8 offen offset:1024 sc1
    buffer_load_dwordx4 v[64:67], v136, s[24:27], s9 offen offset:0 sc1
    buffer_load_dwordx4 v[68:71], v136, s[24:27], s9 offen offset:1024 sc1
    s_add_u32 s7, s7, 1
    s_waitcnt vmcnt(3)
    v_xor_b32 v15, s58, v56
    v_bitop3_b32 v15, v57, s59, v15 bitop3:0xbe
    s_waitcnt vmcnt(2)
    v_bitop3_b32 v15, v60, s58, v15 bitop3:0xbe
    v_bitop3_b32 v15, v61, s59, v15 bitop3:0xbe
    s_waitcnt vmcnt(1)
    v_bitop3_b32 v15, v64, s58, v15 bitop3:0xbe
    v_bitop3_b32 v15, v65, s59, v15 bitop3:0xbe
    s_waitcnt vmcnt(0)
    v_bitop3_b32 v15, v68, s58, v15 bitop3:0xbe
    v_bitop3_b32 v15, v69, s59, v15 bitop3:0xbe
    v_cmp_ne_u32 vcc, 0, v15
    s_cmp_ge_u32 s7, 20000
    s_cbranch_scc1 Lp41
    s_and_b64 exec, exec, vcc
    s_cbranch_execnz Lp40
    s_nop 1
Lp41:
    s_mov_b64 exec, -1
    v_bfe_u32 v72, v1, 3, 2
    v_and_b32 v75, 7, v1
    v_lshl_add_u32 v72, v75, 2, v72
    v_lshrrev_b32 v75, 5, v1
    v_lshl_add_u32 v72, v75, 7, v72
    v_lshlrev_b32 v74, 2, v72
    ds_write_b32 v74, v58 offset:63152
    ds_write_b32 v74, v59 offset:63280
    ds_write_b32 v74, v62 offset:63408
    ds_write_b32 v74, v63 offset:63536
    ds_write_b32 v74, v66 offset:64176
    ds_write_b32 v74, v67 offset:64304
    ds_write_b32 v74, v70 offset:64432
    ds_write_b32 v74, v71 offset:64560
    v_and_b32 v88, 31, v1
    v_lshlrev_b32 v88, 4, v88
    v_lshl_add_u32 v88, v75, 11, v88
    v_add_u32 v88, 65200, v88
    s_cmp_eq_u32 s6, 0
    s_movk_i32 s14, 255
    s_cselect_b32 s14, 256, s14
    s_waitcnt lgkmcnt(0)
    v_sub_u32 v73, s14, v72
    v_subrev_u32 v73, 0, v73
    v_and_b32 v73, 255, v73
    v_lshlrev_b32 v73, 2, v73
    ds_read_b32 v79, v73 offset:63152
    ds_read_b32 v83, v73 offset:64176
    v_mov_b32 v77, v58
    v_mov_b32 v81, v66
    s_waitcnt lgkmcnt(0)
    v_lshlrev_b32 v76, 16, v77
    v_and_b32 v77, s15, v77
    v_lshlrev_b32 v78, 16, v79
    v_and_b32 v79, s15, v79
    v_lshlrev_b32 v80, 16, v81
    v_and_b32 v81, s15, v81
    v_lshlrev_b32 v82, 16, v83
    v_and_b32 v83, s15, v83
    v_pk_add_f32 v[84:85], v[76:77], v[82:83] neg_hi:[0,1]
    v_pk_add_f32 v[86:87], v[80:81], v[78:79] neg_hi:[0,1]
    v_pk_add_f32 v[76:77], v[76:77], v[78:79] neg_hi:[0,1]
    v_pk_add_f32 v[80:81], v[80:81], v[82:83] neg_hi:[0,1]
    v_mul_f32 v84, s28, v84
    v_fmac_f32 v84, s29, v86
    v_mul_f32 v85, s28, v85
    v_fmac_f32 v85, s29, v87
    v_sub_f32 v86, v76, v80
    v_mul_f32 v86, s29, v86
    v_sub_f32 v87, v77, v81
    v_mul_f32 v87, s29, v87
    ds_write_b128 v88, v[84:87] offset:0
    v_sub_u32 v73, s14, v72
    v_subrev_u32 v73, 32, v73
    v_and_b32 v73, 255, v73
    v_lshlrev_b32 v73, 2, v73
    ds_read_b32 v79, v73 offset:63152
    ds_read_b32 v83, v73 offset:64176
    v_mov_b32 v77, v59
    v_mov_b32 v81, v67
    s_waitcnt lgkmcnt(0)
    v_lshlrev_b32 v76, 16, v77
    v_and_b32 v77, s15, v77
    v_lshlrev_b32 v78, 16, v79
    v_and_b32 v79, s15, v79
    v_lshlrev_b32 v80, 16, v81
    v_and_b32 v81, s15, v81
    v_lshlrev_b32 v82, 16, v83
    v_and_b32 v83, s15, v83
    v_pk_add_f32 v[84:85], v[76:77], v[82:83] neg_hi:[0,1]
    v_pk_add_f32 v[86:87], v[80:81], v[78:79] neg_hi:[0,1]
    v_pk_add_f32 v[76:77], v[76:77], v[78:79] neg_hi:[0,1]
    v_pk_add_f32 v[80:81], v[80:81], v[82:83] neg_hi:[0,1]
    v_mul_f32 v84, s28, v84
    v_fmac_f32 v84, s29, v86
    v_mul_f32 v85, s28, v85
    v_fmac_f32 v85, s29, v87
    v_sub_f32 v86, v76, v80
    v_mul_f32 v86, s29, v86
    v_sub_f32 v87, v77, v81
    v_mul_f32 v87, s29, v87
    ds_write_b128 v88, v[84:87] offset:512
    v_sub_u32 v73, s14, v72
    v_subrev_u32 v73, 64, v73
    v_and_b32 v73, 255, v73
    v_lshlrev_b32 v73, 2, v73
    ds_read_b32 v79, v73 offset:63152
    ds_read_b32 v83, v73 offset:64176
    v_mov_b32 v77, v62
    v_mov_b32 v81, v70
    s_waitcnt lgkmcnt(0)
    v_lshlrev_b32 v76, 16, v77
    v_and_b32 v77, s15, v77
    v_lshlrev_b32 v78, 16, v79
    v_and_b32 v79, s15, v79
    v_lshlrev_b32 v80, 16, v81
    v_and_b32 v81, s15, v81
    v_lshlrev_b32 v82, 16, v83
    v_and_b32 v83, s15, v83
    v_pk_add_f32 v[84:85], v[76:77], v[82:83] neg_hi:[0,1]
    v_pk_add_f32 v[86:87], v[80:81], v[78:79] neg_hi:[0,1]
    v_pk_add_f32 v[76:77], v[76:77], v[78:79] neg_hi:[0,1]
    v_pk_add_f32 v[80:81], v[80:81], v[82:83] neg_hi:[0,1]
    v_mul_f32 v84, s28, v84
    v_fmac_f32 v84, s29, v86
    v_mul_f32 v85, s28, v85
    v_fmac_f32 v85, s29, v87
    v_sub_f32 v86, v76, v80
    v_mul_f32 v86, s29, v86
    v_sub_f32 v87, v77, v81
    v_mul_f32 v87, s29, v87
    ds_write_b128 v88, v[84:87] offset:1024
    v_sub_u32 v73, s14, v72
    v_subrev_u32 v73, 96, v73
    v_and_b32 v73, 255, v73
    v_lshlrev_b32 v73, 2, v73
    ds_read_b32 v79, v73 offset:63152
    ds_read_b32 v83, v73 offset:64176
    v_mov_b32 v77, v63
    v_mov_b32 v81, v71
    s_waitcnt lgkmcnt(0)
    v_lshlrev_b32 v76, 16, v77
    v_and_b32 v77, s15, v77
    v_lshlrev_b32 v78, 16, v79
    v_and_b32 v79, s15, v79
    v_lshlrev_b32 v80, 16, v81
    v_and_b32 v81, s15, v81
    v_lshlrev_b32 v82, 16, v83
    v_and_b32 v83, s15, v83
    v_pk_add_f32 v[84:85], v[76:77], v[82:83] neg_hi:[0,1]
    v_pk_add_f32 v[86:87], v[80:81], v[78:79] neg_hi:[0,1]
    v_pk_add_f32 v[76:77], v[76:77], v[78:79] neg_hi:[0,1]
    v_pk_add_f32 v[80:81], v[80:81], v[82:83] neg_hi:[0,1]
    v_mul_f32 v84, s28, v84
    v_fmac_f32 v84, s29, v86
    v_mul_f32 v85, s28, v85
    v_fmac_f32 v85, s29, v87
    v_sub_f32 v86, v76, v80
    v_mul_f32 v86, s29, v86
    v_sub_f32 v87, v77, v81
    v_mul_f32 v87, s29, v87
    ds_write_b128 v88, v[84:87] offset:1536
    s_nop 1
L_nosp:
    s_waitcnt lgkmcnt(0)
    s_barrier
    s_nop 1
L_sb5:
    s_cmp_eq_u32 s2, 0
    s_cselect_b64 exec, 1, 0
    v_mov_b32 v144, s58
    v_mov_b32 v145, s59
    s_mov_b32 s14, 61440
    buffer_store_dwordx2 v[144:145], v136, s[24:27], s14 offen sc1
    s_mov_b64 exec, -1
    v_lshrrev_b32 v181, 4, v1
    v_mul_u32_u24 v180, 327680, v181
    v_mul_u32_u24 v181, 1280, v181
    v_and_b32 v15, 15, v1
    v_lshlrev_b32 v15, 4, v15
    v_add_u32 v15, 1024, v15
    v_add_u32 v180, v180, v15
    v_add_u32 v181, v181, v15
    s_mul_i32 s50, s4, 1280
    s_add_u32 s51, s50, 327680
    s_add_u32 s52, s50, 655360
    s_add_u32 s53, s50, 983040
    s_add_u32 s54, s50, 1310720
    s_add_u32 s55, s50, 1638400
    s_add_u32 s56, s50, 1966080
    s_add_u32 s57, s50, 2293760
    s_add_u32 s16, s84, 0xf00000
    s_addc_u32 s17, s85, 0
    s_mov_b32 s18, 0x280000
    s_mov_b32 s19, 0x00020000
    buffer_store_dwordx4 v[140:143], v136, s[16:19], s50 offen sc1
    buffer_store_dwordx4 v[140:143], v136, s[16:19], s51 offen sc1
    buffer_store_dwordx4 v[140:143], v136, s[16:19], s52 offen sc1
    buffer_store_dwordx4 v[140:143], v136, s[16:19], s53 offen sc1
    buffer_store_dwordx4 v[140:143], v136, s[16:19], s54 offen sc1
    buffer_store_dwordx4 v[140:143], v136, s[16:19], s55 offen sc1
    buffer_store_dwordx4 v[140:143], v136, s[16:19], s56 offen sc1
    buffer_store_dwordx4 v[140:143], v136, s[16:19], s57 offen sc1
    buffer_store_dwordx4 v[140:143], v180, s[16:19], s50 offen sc1
    buffer_store_dwordx4 v[140:143], v180, s[16:19], s54 offen sc1
    v_lshlrev_b32 v182, 12, v1
    s_lshl_b32 s8, s2, 4
    s_add_u32 s8, s8, 131072
    s_mov_b64 exec, 0xff
    buffer_store_dwordx4 v[140:143], v182, s[24:27], s8 offen sc1
    s_lshl_b32 s8, s4, 10
    s_add_u32 s8, s8, 180224
    s_cmp_lt_u32 s4, 10
    s_cselect_b64 exec, -1, 0
    buffer_store_dwordx4 v[140:143], v136, s[24:27], s8 offen sc1
    s_mov_b64 exec, -1
    s_mov_b32 s20, s68
    s_mov_b32 s21, s69
    s_mov_b32 s22, 0x500
    s_mov_b32 s23, 0x00020000
    v_lshlrev_b32 v182, 2, v1
    buffer_load_dword v144, v182, s[20:23], 0 offen offset:0
    buffer_load_dword v145, v182, s[20:23], 0 offen offset:256
    buffer_load_dword v146, v182, s[20:23], 0 offen offset:512
    buffer_load_dword v147, v182, s[20:23], 0 offen offset:768
    buffer_load_dword v148, v182, s[20:23], 0 offen offset:1024
    s_getpc_b64 s[32:33]
LLpc43:
    s_add_u32 s32, s32, fused_kernel-LLpc43
    s_addc_u32 s33, s33, -1
    s_mov_b32 s34, code_end-fused_kernel
    s_mov_b32 s35, 0x00020000
    s_lshl_b32 s49, s5, 10
    s_add_u32 s49, s49, 4096
    v_lshlrev_b32 v248, 4, v1
    buffer_load_dwordx4 v[248:251], v248, s[32:35], s49 offen
    v_lshlrev_b32 v182, 3, v1
    v_add_u32 v182, 60592, v182
    s_waitcnt vmcnt(0)
    v_lshlrev_b32 v96, 16, v144
    v_and_b32 v97, s15, v144
    ds_write_b64 v182, v[96:97] offset:0
    v_lshlrev_b32 v98, 16, v145
    v_and_b32 v99, s15, v145
    ds_write_b64 v182, v[98:99] offset:512
    v_lshlrev_b32 v100, 16, v146
    v_and_b32 v101, s15, v146
    ds_write_b64 v182, v[100:101] offset:1024
    v_lshlrev_b32 v102, 16, v147
    v_and_b32 v103, s15, v147
    ds_write_b64 v182, v[102:103] offset:1536
    v_lshlrev_b32 v104, 16, v148
    v_and_b32 v105, s15, v148
    ds_write_b64 v182, v[104:105] offset:2048
    s_waitcnt lgkmcnt(0)
    s_barrier
    s_mov_b32 s9, 163840
    s_mov_b32 s10, 167936
    s_mov_b32 s11, 172032
    buffer_load_dwordx4 v[56:59], v136, s[24:27], s9 offen offset:0 sc1
    buffer_load_dwordx4 v[60:63], v136, s[24:27], s9 offen offset:1024 sc1
    buffer_load_dwordx4 v[64:67], v136, s[24:27], s9 offen offset:2048 sc1
    buffer_load_dwordx4 v[68:71], v136, s[24:27], s9 offen offset:3072 sc1
    buffer_load_dwordx4 v[72:75], v136, s[24:27], s10 offen offset:0 sc1
    buffer_load_dwordx4 v[76:79], v136, s[24:27], s10 offen offset:1024 sc1
    buffer_load_dwordx4 v[80:83], v136, s[24:27], s10 offen offset:2048 sc1
    buffer_load_dwordx4 v[84:87], v136, s[24:27], s10 offen offset:3072 sc1
    buffer_load_dwordx4 v[88:91], v136, s[24:27], s11 offen offset:0 sc1
    buffer_load_dwordx4 v[92:95], v136, s[24:27], s11 offen offset:1024 sc1
    v_lshlrev_b32 v182, 2, v1
    v_mov_b32 v15, 0
    s_mov_b64 exec, 0x3ff
    ds_write_b32 v182, v15 offset:45056
    s_mov_b64 exec, -1
    s_mov_b32 s7, 0
    s_branch Lp46
    s_nop 1
Lp44:
    buffer_load_dwordx4 v[56:59], v136, s[24:27], s9 offen offset:0 sc1
    buffer_load_dwordx4 v[60:63], v136, s[24:27], s9 offen offset:1024 sc1
    buffer_load_dwordx4 v[64:67], v136, s[24:27], s9 offen offset:2048 sc1
    buffer_load_dwordx4 v[68:71], v136, s[24:27], s9 offen offset:3072 sc1
    buffer_load_dwordx4 v[72:75], v136, s[24:27], s10 offen offset:0 sc1
    buffer_load_dwordx4 v[76:79], v136, s[24:27], s10 offen offset:1024 sc1
    buffer_load_dwordx4 v[80:83], v136, s[24:27], s10 offen offset:2048 sc1
    buffer_load_dwordx4 v[84:87], v136, s[24:27], s10 offen offset:3072 sc1
    buffer_load_dwordx4 v[88:91], v136, s[24:27], s11 offen offset:0 sc1
    buffer_load_dwordx4 v[92:95], v136, s[24:27], s11 offen offset:1024 sc1
    s_nop 1
Lp46:
    s_add_u32 s7, s7, 1
    s_waitcnt vmcnt(9)
    v_xor_b32 v15, s58, v56
    v_bitop3_b32 v15, v57, s59, v15 bitop3:0xbe
    s_waitcnt vmcnt(8)
    v_bitop3_b32 v15, v60, s58, v15 bitop3:0xbe
    v_bitop3_b32 v15, v61, s59, v15 bitop3:0xbe
    s_waitcnt vmcnt(7)
    v_bitop3_b32 v15, v64, s58, v15 bitop3:0xbe
    v_bitop3_b32 v15, v65, s59, v15 bitop3:0xbe
    s_waitcnt vmcnt(6)
    v_bitop3_b32 v15, v68, s58, v15 bitop3:0xbe
    v_bitop3_b32 v15, v69, s59, v15 bitop3:0xbe
    s_waitcnt vmcnt(5)
    v_bitop3_b32 v15, v72, s58, v15 bitop3:0xbe
    v_bitop3_b32 v15, v73, s59, v15 bitop3:0xbe
    s_waitcnt vmcnt(4)
    v_bitop3_b32 v15, v76, s58, v15 bitop3:0xbe
    v_bitop3_b32 v15, v77, s59, v15 bitop3:0xbe
    s_waitcnt vmcnt(3)
    v_bitop3_b32 v15, v80, s58, v15 bitop3:0xbe
    v_bitop3_b32 v15, v81, s59, v15 bitop3:0xbe
    s_waitcnt vmcnt(2)
    v_bitop3_b32 v15, v84, s58, v15 bitop3:0xbe
    v_bitop3_b32 v15, v85, s59, v15 bitop3:0xbe
    s_waitcnt vmcnt(1)
    v_bitop3_b32 v15, v88, s58, v15 bitop3:0xbe
    v_bitop3_b32 v15, v89, s59, v15 bitop3:0xbe
    s_waitcnt vmcnt(0)
    v_bitop3_b32 v15, v92, s58, v15 bitop3:0xbe
    v_bitop3_b32 v15, v93, s59, v15 bitop3:0xbe
    v_cmp_ne_u32 vcc, 0, v15
    s_cmp_ge_u32 s7, 20000
    s_cbranch_scc1 Lp45
    s_and_b64 exec, exec, vcc
    s_cbranch_execnz Lp44
    s_nop 1
Lp45:
    s_mov_b64 exec, -1
    v_lshlrev_b32 v56, 16, v58
    v_and_b32 v57, s15, v58
    v_lshlrev_b32 v58, 16, v59
    v_and_b32 v59, s15, v59
    ds_write_b128 v136, v[56:59] offset:50352
    v_lshlrev_b32 v60, 16, v62
    v_and_b32 v61, s15, v62
    v_lshlrev_b32 v62, 16, v63
    v_and_b32 v63, s15, v63
    ds_write_b128 v136, v[60:63] offset:51376
    v_lshlrev_b32 v64, 16, v66
    v_and_b32 v65, s15, v66
    v_lshlrev_b32 v66, 16, v67
    v_and_b32 v67, s15, v67
    ds_write_b128 v136, v[64:67] offset:52400
    v_lshlrev_b32 v68, 16, v70
    v_and_b32 v69, s15, v70
    v_lshlrev_b32 v70, 16, v71
    v_and_b32 v71, s15, v71
    ds_write_b128 v136, v[68:71] offset:53424
    v_lshlrev_b32 v72, 16, v74
    v_and_b32 v73, s15, v74
    v_lshlrev_b32 v74, 16, v75
    v_and_b32 v75, s15, v75
    ds_write_b128 v136, v[72:75] offset:54448
    v_lshlrev_b32 v76, 16, v78
    v_and_b32 v77, s15, v78
    v_lshlrev_b32 v78, 16, v79
    v_and_b32 v79, s15, v79
    ds_write_b128 v136, v[76:79] offset:55472
    v_lshlrev_b32 v80, 16, v82
    v_and_b32 v81, s15, v82
    v_lshlrev_b32 v82, 16, v83
    v_and_b32 v83, s15, v83
    ds_write_b128 v136, v[80:83] offset:56496
    v_lshlrev_b32 v84, 16, v86
    v_and_b32 v85, s15, v86
    v_lshlrev_b32 v86, 16, v87
    v_and_b32 v87, s15, v87
    ds_write_b128 v136, v[84:87] offset:57520
    v_lshlrev_b32 v88, 16, v90
    v_and_b32 v89, s15, v90
    v_lshlrev_b32 v90, 16, v91
    v_and_b32 v91, s15, v91
    ds_write_b128 v136, v[88:91] offset:58544
    v_lshlrev_b32 v92, 16, v94
    v_and_b32 v93, s15, v94
    v_lshlrev_b32 v94, 16, v95
    v_and_b32 v95, s15, v95
    ds_write_b128 v136, v[92:95] offset:59568
    s_waitcnt lgkmcnt(0)
    s_barrier
    s_waitcnt lgkmcnt(0)
    s_barrier
    s_mov_b32 s32, s70
    s_mov_b32 s33, s71
    s_mov_b32 s49, s5
    s_mul_i32 s28, s49, 26
    s_lshr_b32 s28, s28, 8
    s_mul_i32 s29, s28, 10
    s_sub_u32 s49, s49, s29
    s_lshl_b32 s28, s28, 3
    s_add_u32 s28, s28, s6
    s_cmp_lt_u32 s28, 27
    s_cselect_b32 s34, 2211840, 0
    s_mov_b32 s35, 0x00020000
    s_mul_i32 s29, s49, 221184
    s_lshl_b32 s28, s28, 7
    s_add_u32 s29, s29, s28
    buffer_load_dword v156, v154, s[32:35], s29 offen
    s_mov_b32 s32, s72
    s_mov_b32 s33, s73
    s_mov_b32 s49, s5
    s_mul_i32 s28, s49, 26
    s_lshr_b32 s28, s28, 8
    s_mul_i32 s29, s28, 10
    s_sub_u32 s49, s49, s29
    s_lshl_b32 s28, s28, 3
    s_add_u32 s28, s28, s6
    s_cmp_lt_u32 s28, 27
    s_cselect_b32 s34, 2211840, 0
    s_mov_b32 s35, 0x00020000
    s_mul_i32 s29, s49, 221184
    s_lshl_b32 s28, s28, 7
    s_add_u32 s29, s29, s28
    buffer_load_dword v156, v154, s[32:35], s29 offen
    s_mov_b32 s32, s74
    s_mov_b32 s33, s75
    s_mov_b32 s49, s5
    s_mul_i32 s28, s49, 26
    s_lshr_b32 s28, s28, 8
    s_mul_i32 s29, s28, 10
    s_sub_u32 s49, s49, s29
    s_lshl_b32 s28, s28, 3
    s_add_u32 s28, s28, s6
    s_cmp_lt_u32 s28, 27
    s_cselect_b32 s34, 2211840, 0
    s_mov_b32 s35, 0x00020000
    s_mul_i32 s29, s28, 81920
    s_lshl_b32 s49, s49, 13
    s_add_u32 s29, s29, s49
    buffer_load_dword v156, v155, s[32:35], s29 offen
    s_lshr_b32 s28, s5, 3
    s_cmp_eq_u32 s28, 0
    s_cselect_b64 s[32:33], s[70:71], s[72:73]
    s_cmp_ge_u32 s28, 2
    s_cselect_b64 s[32:33], s[74:75], s[32:33]
    s_and_b32 s49, s5, 7
    s_add_u32 s49, s49, 32
    s_mul_i32 s28, s49, 26
    s_lshr_b32 s28, s28, 8
    s_mul_i32 s29, s28, 10
    s_sub_u32 s49, s49, s29
    s_lshl_b32 s28, s28, 3
    s_add_u32 s28, s28, s6
    s_cmp_lt_u32 s28, 27
    s_cselect_b32 s34, 2211840, 0
    s_mov_b32 s35, 0x00020000
    s_cmp_lt_u32 s5, 24
    s_cselect_b32 s34, s34, 0
    s_cmp_ge_u32 s5, 16
    s_cbranch_scc1 Lf47
    s_mul_i32 s29, s49, 221184
    s_lshl_b32 s28, s28, 7
    s_add_u32 s29, s29, s28
    buffer_load_dword v156, v154, s[32:35], s29 offen
    s_branch Lf48
    s_nop 1
Lf47:
    s_mul_i32 s29, s28, 81920
    s_lshl_b32 s49, s49, 13
    s_add_u32 s29, s29, s49
    buffer_load_dword v156, v155, s[32:35], s29 offen
    s_nop 1
Lf48:
    s_waitcnt lgkmcnt(0)
    s_barrier
    s_mov_b32 vcc_lo, 0x5aa55aa5
    s_mov_b32 vcc_hi, 0x5aa55aa5
    v_cndmask_b32_e64 v186, 0, -1, vcc
    s_mov_b32 vcc_lo, 0x3cc33cc3
    s_mov_b32 vcc_hi, 0x3cc33cc3
    v_cndmask_b32_e64 v187, 0, -1, vcc
    s_mov_b32 vcc_lo, 0xf00ff00f
    s_mov_b32 vcc_hi, 0xf00ff00f
    v_cndmask_b32_e64 v188, 0, -1, vcc
    v_and_b32 v183, 7, v1
    v_and_b32 v184, 8, v1
    v_lshl_add_u32 v183, v184, 1, v183
    v_lshlrev_b32 v183, 2, v183
    v_add_u32 v183, 44928, v183
    v_add_u32 v184, 130736, v136
    v_lshlrev_b32 v182, 12, v1
    s_lshl_b32 s8, s2, 4
    s_add_u32 s8, s8, 131072
    v_mov_b32 v15, 0
    s_waitcnt lgkmcnt(0)
    s_barrier
    ds_read_b128 v[56:59], v136 offset:29440
    ds_read_b128 v[60:63], v136 offset:30720
    ds_read_b128 v[64:67], v136 offset:32000
    ds_read_b128 v[68:71], v136 offset:33280
    ds_read_b128 v[72:75], v181 offset:29440
    s_waitcnt lgkmcnt(4)
    buffer_store_dwordx4 v[56:59], v136, s[16:19], s54 offen sc1
    s_waitcnt lgkmcnt(3)
    buffer_store_dwordx4 v[60:63], v136, s[16:19], s55 offen sc1
    s_waitcnt lgkmcnt(2)
    buffer_store_dwordx4 v[64:67], v136, s[16:19], s56 offen sc1
    s_waitcnt lgkmcnt(1)
    buffer_store_dwordx4 v[68:71], v136, s[16:19], s57 offen sc1
    s_waitcnt lgkmcnt(0)
    buffer_store_dwordx4 v[72:75], v180, s[16:19], s54 offen sc1
    s_nop 1
Lw49:
    ds_read_b32 v185, v15 offset:45088
    s_waitcnt lgkmcnt(0)
    v_readfirstlane_b32 s14, v185
    s_cmp_eq_u32 s14, 0
    s_cbranch_scc1 Lw49
    s_cmp_eq_u32 s31, 0
    s_cbranch_scc1 L_nodma
    s_mov_b32 m0, 69296
    s_lshl_b32 s48, s30, 5
    buffer_load_dwordx4 v152, s[36:39], s48 offen lds
    s_mov_b32 m0, 70320
    s_add_u32 s48, s48, 110592
    buffer_load_dwordx4 v152, s[36:39], s48 offen lds
    s_mov_b32 m0, 71344
    s_add_u32 s48, s48, 110592
    buffer_load_dwordx4 v152, s[36:39], s48 offen lds
    s_mov_b32 m0, 72368
    s_add_u32 s48, s48, 110592
    buffer_load_dwordx4 v152, s[36:39], s48 offen lds
    s_mov_b32 m0, 73392
    s_add_u32 s48, s48, 110592
    buffer_load_dwordx4 v152, s[36:39], s48 offen lds
    s_mov_b32 m0, 74416
    s_add_u32 s48, s48, 110592
    buffer_load_dwordx4 v152, s[36:39], s48 offen lds
    s_mov_b32 m0, 75440
    s_add_u32 s48, s48, 110592
    buffer_load_dwordx4 v152, s[36:39], s48 offen lds
    s_mov_b32 m0, 76464
    s_add_u32 s48, s48, 110592
    buffer_load_dwordx4 v152, s[36:39], s48 offen lds
    s_mov_b32 m0, 77488
    s_add_u32 s48, s48, 110592
    buffer_load_dwordx4 v152, s[36:39], s48 offen lds
    s_mov_b32 m0, 78512
    s_add_u32 s48, s48, 110592
    buffer_load_dwordx4 v152, s[36:39], s48 offen lds
    s_mov_b32 m0, 79536
    s_add_u32 s48, s48, 110592
    buffer_load_dwordx4 v152, s[36:39], s48 offen lds
    s_mov_b32 m0, 80560
    s_add_u32 s48, s48, 110592
    buffer_load_dwordx4 v152, s[36:39], s48 offen lds
    s_mov_b32 m0, 81584
    s_add_u32 s48, s48, 110592
    buffer_load_dwordx4 v152, s[36:39], s48 offen lds
    s_mov_b32 m0, 82608
    s_add_u32 s48, s48, 110592
    buffer_load_dwordx4 v152, s[36:39], s48 offen lds
    s_mov_b32 m0, 83632
    s_add_u32 s48, s48, 110592
    buffer_load_dwordx4 v152, s[36:39], s48 offen lds
    s_mov_b32 m0, 84656
    s_add_u32 s48, s48, 110592
    buffer_load_dwordx4 v152, s[36:39], s48 offen lds
    s_mov_b32 m0, 85680
    s_add_u32 s48, s48, 110592
    buffer_load_dwordx4 v152, s[36:39], s48 offen lds
    s_mov_b32 m0, 86704
    s_add_u32 s48, s48, 110592
    buffer_load_dwordx4 v152, s[36:39], s48 offen lds
    s_mov_b32 m0, 87728
    s_add_u32 s48, s48, 110592
    buffer_load_dwordx4 v152, s[36:39], s48 offen lds
    s_mov_b32 m0, 88752
    s_add_u32 s48, s48, 110592
    buffer_load_dwordx4 v152, s[36:39], s48 offen lds
    s_mov_b32 m0, 89776
    s_lshl_b32 s48, s30, 5
    buffer_load_dwordx4 v152, s[40:43], s48 offen lds
    s_mov_b32 m0, 90800
    s_add_u32 s48, s48, 110592
    buffer_load_dwordx4 v152, s[40:43], s48 offen lds
    s_mov_b32 m0, 91824
    s_add_u32 s48, s48, 110592
    buffer_load_dwordx4 v152, s[40:43], s48 offen lds
    s_mov_b32 m0, 92848
    s_add_u32 s48, s48, 110592
    buffer_load_dwordx4 v152, s[40:43], s48 offen lds
    s_mov_b32 m0, 93872
    s_add_u32 s48, s48, 110592
    buffer_load_dwordx4 v152, s[40:43], s48 offen lds
    s_mov_b32 m0, 94896
    s_add_u32 s48, s48, 110592
    buffer_load_dwordx4 v152, s[40:43], s48 offen lds
    s_mov_b32 m0, 95920
    s_add_u32 s48, s48, 110592
    buffer_load_dwordx4 v152, s[40:43], s48 offen lds
    s_mov_b32 m0, 96944
    s_add_u32 s48, s48, 110592
    buffer_load_dwordx4 v152, s[40:43], s48 offen lds
    s_mov_b32 m0, 97968
    s_add_u32 s48, s48, 110592
    buffer_load_dwordx4 v152, s[40:43], s48 offen lds
    s_mov_b32 m0, 98992
    s_add_u32 s48, s48, 110592
    buffer_load_dwordx4 v152, s[40:43], s48 offen lds
    s_mov_b32 m0, 100016
    s_add_u32 s48, s48, 110592
    buffer_load_dwordx4 v152, s[40:43], s48 offen lds
    s_mov_b32 m0, 101040
    s_add_u32 s48, s48, 110592
    buffer_load_dwordx4 v152, s[40:43], s48 offen lds
    s_mov_b32 m0, 102064
    s_add_u32 s48, s48, 110592
    buffer_load_dwordx4 v152, s[40:43], s48 offen lds
    s_mov_b32 m0, 103088
    s_add_u32 s48, s48, 110592
    buffer_load_dwordx4 v152, s[40:43], s48 offen lds
    s_mov_b32 m0, 104112
    s_add_u32 s48, s48, 110592
    buffer_load_dwordx4 v152, s[40:43], s48 offen lds
    s_mov_b32 m0, 105136
    s_add_u32 s48, s48, 110592
    buffer_load_dwordx4 v152, s[40:43], s48 offen lds
    s_mov_b32 m0, 106160
    s_add_u32 s48, s48, 110592
    buffer_load_dwordx4 v152, s[40:43], s48 offen lds
    s_mov_b32 m0, 107184
    s_add_u32 s48, s48, 110592
    buffer_load_dwordx4 v152, s[40:43], s48 offen lds
    s_mov_b32 m0, 108208
    s_add_u32 s48, s48, 110592
    buffer_load_dwordx4 v152, s[40:43], s48 offen lds
    s_mov_b32 m0, 109232
    s_add_u32 s48, s48, 110592
    buffer_load_dwordx4 v152, s[40:43], s48 offen lds
    s_mov_b32 m0, 110256
    s_mul_i32 s48, s30, 20480
    buffer_load_dwordx4 v153, s[44:47], s48 offen lds
    s_mov_b32 m0, 111280
    s_add_u32 s48, s48, 64
    buffer_load_dwordx4 v153, s[44:47], s48 offen lds
    s_mov_b32 m0, 112304
    s_add_u32 s48, s48, 64
    buffer_load_dwordx4 v153, s[44:47], s48 offen lds
    s_mov_b32 m0, 113328
    s_add_u32 s48, s48, 64
    buffer_load_dwordx4 v153, s[44:47], s48 offen lds
    s_mov_b32 m0, 114352
    s_add_u32 s48, s48, 64
    buffer_load_dwordx4 v153, s[44:47], s48 offen lds
    s_mov_b32 m0, 115376
    s_add_u32 s48, s48, 64
    buffer_load_dwordx4 v153, s[44:47], s48 offen lds
    s_mov_b32 m0, 116400
    s_add_u32 s48, s48, 64
    buffer_load_dwordx4 v153, s[44:47], s48 offen lds
    s_mov_b32 m0, 117424
    s_add_u32 s48, s48, 64
    buffer_load_dwordx4 v153, s[44:47], s48 offen lds
    s_mov_b32 m0, 118448
    s_add_u32 s48, s48, 64
    buffer_load_dwordx4 v153, s[44:47], s48 offen lds
    s_mov_b32 m0, 119472
    s_add_u32 s48, s48, 64
    buffer_load_dwordx4 v153, s[44:47], s48 offen lds
    s_mov_b32 m0, 120496
    s_add_u32 s48, s48, 64
    buffer_load_dwordx4 v153, s[44:47], s48 offen lds
    s_mov_b32 m0, 121520
    s_add_u32 s48, s48, 64
    buffer_load_dwordx4 v153, s[44:47], s48 offen lds
    s_mov_b32 m0, 122544
    s_add_u32 s48, s48, 64
    buffer_load_dwordx4 v153, s[44:47], s48 offen lds
    s_mov_b32 m0, 123568
    s_add_u32 s48, s48, 64
    buffer_load_dwordx4 v153, s[44:47], s48 offen lds
    s_mov_b32 m0, 124592
    s_add_u32 s48, s48, 64
    buffer_load_dwordx4 v153, s[44:47], s48 offen lds
    s_mov_b32 m0, 125616
    s_add_u32 s48, s48, 64
    buffer_load_dwordx4 v153, s[44:47], s48 offen lds
    s_mov_b32 m0, 126640
    s_add_u32 s48, s48, 64
    buffer_load_dwordx4 v153, s[44:47], s48 offen lds
    s_mov_b32 m0, 127664
    s_add_u32 s48, s48, 64
    buffer_load_dwordx4 v153, s[44:47], s48 offen lds
    s_mov_b32 m0, 128688
    s_add_u32 s48, s48, 64
    buffer_load_dwordx4 v153, s[44:47], s48 offen lds
    s_mov_b32 m0, 129712
    s_add_u32 s48, s48, 64
    buffer_load_dwordx4 v153, s[44:47], s48 offen lds
    s_nop 1
L_nodma:
    s_mov_b32 s20, s80
    s_mov_b32 s21, s81
    s_mov_b32 s22, 0x280000
    s_mov_b32 s23, 0x00020000
    s_waitcnt lgkmcnt(0)
    s_barrier
    s_waitcnt vmcnt(0)
    s_mov_b64 exec, 1
    ds_write_b32 v15, v31 offset:45092
    s_mov_b64 exec, -1
    ds_read2_b32 v[144:145], v183 offset0:0 offset1:8
    s_waitcnt lgkmcnt(0)
    v_max_u32 v144, v144, v145
    s_nop 1
    v_mov_b32_dpp v145, v144 quad_perm:[1,0,3,2] row_mask:0xf bank_mask:0xf
    v_med3_u32 v144, v144, v145, v186
    s_nop 1
    v_mov_b32_dpp v145, v144 quad_perm:[2,3,0,1] row_mask:0xf bank_mask:0xf
    v_med3_u32 v144, v144, v145, v187
    s_nop 1
    v_mov_b32_dpp v145, v144 row_half_mirror row_mask:0xf bank_mask:0xf
    v_med3_u32 v144, v144, v145, v188
    s_nop 1
    v_max_u32_dpp v144, v144, v144 row_ror:8 row_mask:0xf bank_mask:0xf
    s_nop 0
    v_readlane_b32 s36, v144, 0
    v_readlane_b32 s37, v144, 1
    v_readlane_b32 s38, v144, 2
    v_readlane_b32 s39, v144, 3
    v_readlane_b32 s40, v144, 4
    v_readlane_b32 s41, v144, 5
    v_readlane_b32 s42, v144, 6
    v_readlane_b32 s43, v144, 7
    s_mov_b32 s30, 0
    s_not_b32 s8, s36
    s_and_b32 s9, s8, 0xff
    s_cmp_lg_u32 s9, s4
    s_cbranch_scc1 Ls50
    s_bfe_u32 s8, s8, 0x30008
    s_bitset1_b32 s30, s8
    s_mul_i32 s8, s8, 1280
    v_add_u32 v185, s8, v184
    ds_read_b128 v[56:59], v185
    ds_read_b128 v[60:63], v185 offset:1024
    s_mov_b32 s8, 180224
    s_waitcnt lgkmcnt(0)
    buffer_store_dwordx4 v[56:59], v136, s[24:27], s8 offen sc1
    s_mov_b64 exec, 0xffff
    buffer_store_dwordx4 v[60:63], v136, s[24:27], s8 offen offset:1024 sc1
    s_mov_b64 exec, -1
    s_nop 1
    s_nop 1
Ls50:
    s_not_b32 s8, s37
    s_and_b32 s9, s8, 0xff
    s_cmp_lg_u32 s9, s4
    s_cbranch_scc1 Ls51
    s_bfe_u32 s8, s8, 0x30008
    s_bitset1_b32 s30, s8
    s_mul_i32 s8, s8, 1280
    v_add_u32 v185, s8, v184
    ds_read_b128 v[56:59], v185
    ds_read_b128 v[60:63], v185 offset:1024
    s_mov_b32 s8, 181504
    s_waitcnt lgkmcnt(0)
    buffer_store_dwordx4 v[56:59], v136, s[24:27], s8 offen sc1
    s_mov_b64 exec, 0xffff
    buffer_store_dwordx4 v[60:63], v136, s[24:27], s8 offen offset:1024 sc1
    s_mov_b64 exec, -1
    s_nop 1
    s_nop 1
Ls51:
    s_not_b32 s8, s38
    s_and_b32 s9, s8, 0xff
    s_cmp_lg_u32 s9, s4
    s_cbranch_scc1 Ls52
    s_bfe_u32 s8, s8, 0x30008
    s_bitset1_b32 s30, s8
    s_mul_i32 s8, s8, 1280
    v_add_u32 v185, s8, v184
    ds_read_b128 v[56:59], v185
    ds_read_b128 v[60:63], v185 offset:1024
    s_mov_b32 s8, 182784
    s_waitcnt lgkmcnt(0)
    buffer_store_dwordx4 v[56:59], v136, s[24:27], s8 offen sc1
    s_mov_b64 exec, 0xffff
    buffer_store_dwordx4 v[60:63], v136, s[24:27], s8 offen offset:1024 sc1
    s_mov_b64 exec, -1
    s_nop 1
    s_nop 1
Ls52:
    s_not_b32 s8, s39
    s_and_b32 s9, s8, 0xff
    s_cmp_lg_u32 s9, s4
    s_cbranch_scc1 Ls53
    s_bfe_u32 s8, s8, 0x30008
    s_bitset1_b32 s30, s8
    s_mul_i32 s8, s8, 1280
    v_add_u32 v185, s8, v184
    ds_read_b128 v[56:59], v185
    ds_read_b128 v[60:63], v185 offset:1024
    s_mov_b32 s8, 184064
    s_waitcnt lgkmcnt(0)
    buffer_store_dwordx4 v[56:59], v136, s[24:27], s8 offen sc1
    s_mov_b64 exec, 0xffff
    buffer_store_dwordx4 v[60:63], v136, s[24:27], s8 offen offset:1024 sc1
    s_mov_b64 exec, -1
    s_nop 1
    s_nop 1
Ls53:
    s_not_b32 s8, s40
    s_and_b32 s9, s8, 0xff
    s_cmp_lg_u32 s9, s4
    s_cbranch_scc1 Ls54
    s_bfe_u32 s8, s8, 0x30008
    s_bitset1_b32 s30, s8
    s_mul_i32 s8, s8, 1280
    v_add_u32 v185, s8, v184
    ds_read_b128 v[56:59], v185
    ds_read_b128 v[60:63], v185 offset:1024
    s_mov_b32 s8, 185344
    s_waitcnt lgkmcnt(0)
    buffer_store_dwordx4 v[56:59], v136, s[24:27], s8 offen sc1
    s_mov_b64 exec, 0xffff
    buffer_store_dwordx4 v[60:63], v136, s[24:27], s8 offen offset:1024 sc1
    s_mov_b64 exec, -1
    s_nop 1
    s_nop 1
Ls54:
    s_not_b32 s8, s41
    s_and_b32 s9, s8, 0xff
    s_cmp_lg_u32 s9, s4
    s_cbranch_scc1 Ls55
    s_bfe_u32 s8, s8, 0x30008
    s_bitset1_b32 s30, s8
    s_mul_i32 s8, s8, 1280
    v_add_u32 v185, s8, v184
    ds_read_b128 v[56:59], v185
    ds_read_b128 v[60:63], v185 offset:1024
    s_mov_b32 s8, 186624
    s_waitcnt lgkmcnt(0)
    buffer_store_dwordx4 v[56:59], v136, s[24:27], s8 offen sc1
    s_mov_b64 exec, 0xffff
    buffer_store_dwordx4 v[60:63], v136, s[24:27], s8 offen offset:1024 sc1
    s_mov_b64 exec, -1
    s_nop 1
    s_nop 1
Ls55:
    s_not_b32 s8, s42
    s_and_b32 s9, s8, 0xff
    s_cmp_lg_u32 s9, s4
    s_cbranch_scc1 Ls56
    s_bfe_u32 s8, s8, 0x30008
    s_bitset1_b32 s30, s8
    s_mul_i32 s8, s8, 1280
    v_add_u32 v185, s8, v184
    ds_read_b128 v[56:59], v185
    ds_read_b128 v[60:63], v185 offset:1024
    s_mov_b32 s8, 187904
    s_waitcnt lgkmcnt(0)
    buffer_store_dwordx4 v[56:59], v136, s[24:27], s8 offen sc1
    s_mov_b64 exec, 0xffff
    buffer_store_dwordx4 v[60:63], v136, s[24:27], s8 offen offset:1024 sc1
    s_mov_b64 exec, -1
    s_nop 1
    s_nop 1
Ls56:
    s_not_b32 s8, s43
    s_and_b32 s9, s8, 0xff
    s_cmp_lg_u32 s9, s4
    s_cbranch_scc1 Ls57
    s_bfe_u32 s8, s8, 0x30008
    s_bitset1_b32 s30, s8
    s_mul_i32 s8, s8, 1280
    v_add_u32 v185, s8, v184
    ds_read_b128 v[56:59], v185
    ds_read_b128 v[60:63], v185 offset:1024
    s_mov_b32 s8, 189184
    s_waitcnt lgkmcnt(0)
    buffer_store_dwordx4 v[56:59], v136, s[24:27], s8 offen sc1
    s_mov_b64 exec, 0xffff
    buffer_store_dwordx4 v[60:63], v136, s[24:27], s8 offen offset:1024 sc1
    s_mov_b64 exec, -1
    s_nop 1
    s_nop 1
Ls57:
    ds_read_b128 v[64:67], v136 offset:34560
    ds_read_b128 v[68:71], v136 offset:35840
    ds_read_b128 v[72:75], v136 offset:37120
    ds_read_b128 v[76:79], v136 offset:38400
    ds_read_b128 v[80:83], v136 offset:39680
    ds_read_b128 v[84:87], v136 offset:40960
    ds_read_b128 v[88:91], v136 offset:42240
    ds_read_b128 v[92:95], v136 offset:43520
    ds_read_b128 v[96:99], v181 offset:34560
    ds_read_b128 v[100:103], v181 offset:39680
    v_lshrrev_b32 v185, 4, v1
    v_lshrrev_b32 v185, v185, s30
    s_bitcmp0_b32 s30, 0
    s_cselect_b64 exec, -1, 0
    s_waitcnt lgkmcnt(9)
    buffer_store_dwordx4 v[64:67], v136, s[20:23], s50 offen sc1 nt
    s_bitcmp0_b32 s30, 1
    s_cselect_b64 exec, -1, 0
    s_waitcnt lgkmcnt(8)
    buffer_store_dwordx4 v[68:71], v136, s[20:23], s51 offen sc1 nt
    s_bitcmp0_b32 s30, 2
    s_cselect_b64 exec, -1, 0
    s_waitcnt lgkmcnt(7)
    buffer_store_dwordx4 v[72:75], v136, s[20:23], s52 offen sc1 nt
    s_bitcmp0_b32 s30, 3
    s_cselect_b64 exec, -1, 0
    s_waitcnt lgkmcnt(6)
    buffer_store_dwordx4 v[76:79], v136, s[20:23], s53 offen sc1 nt
    s_bitcmp0_b32 s30, 4
    s_cselect_b64 exec, -1, 0
    s_waitcnt lgkmcnt(5)
    buffer_store_dwordx4 v[80:83], v136, s[20:23], s54 offen sc1 nt
    s_bitcmp0_b32 s30, 5
    s_cselect_b64 exec, -1, 0
    s_waitcnt lgkmcnt(4)
    buffer_store_dwordx4 v[84:87], v136, s[20:23], s55 offen sc1 nt
    s_bitcmp0_b32 s30, 6
    s_cselect_b64 exec, -1, 0
    s_waitcnt lgkmcnt(3)
    buffer_store_dwordx4 v[88:91], v136, s[20:23], s56 offen sc1 nt
    s_bitcmp0_b32 s30, 7
    s_cselect_b64 exec, -1, 0
    s_waitcnt lgkmcnt(2)
    buffer_store_dwordx4 v[92:95], v136, s[20:23], s57 offen sc1 nt
    s_mov_b64 exec, -1
    v_and_b32 v184, 1, v185
    v_cmp_eq_u32 vcc, 0, v184
    s_mov_b64 exec, vcc
    s_waitcnt lgkmcnt(1)
    buffer_store_dwordx4 v[96:99], v180, s[20:23], s50 offen sc1 nt
    s_mov_b64 exec, -1
    v_and_b32 v184, 16, v185
    v_cmp_eq_u32 vcc, 0, v184
    s_mov_b64 exec, vcc
    s_waitcnt lgkmcnt(0)
    buffer_store_dwordx4 v[100:103], v180, s[20:23], s54 offen sc1 nt
    s_mov_b64 exec, -1
    s_nop 1
L_end:
L_exit:
    s_endpgm
code_end:
.section .rodata,"a"
.p2align 6
.amdhsa_kernel fused_kernel
  .amdhsa_next_free_vgpr 252
  .amdhsa_next_free_sgpr 88
  .amdhsa_accum_offset 252
  .amdhsa_group_segment_fixed_size 0
  .amdhsa_kernarg_size 104
  .amdhsa_user_sgpr_count 2
  .amdhsa_user_sgpr_kernarg_segment_ptr 1
  .amdhsa_system_sgpr_workgroup_id_x 1
  .amdhsa_float_denorm_mode_32 3
.end_amdhsa_kernel
```
